```python
import torch

def _softmax(x, axis=-1):
    return torch.softmax(x, dim=axis)
def _gelu(x):
    return torch.nn.functional.gelu(x, approximate="tanh")
def _silu(x):
    return torch.nn.functional.silu(x)
def _sigmoid(x):
    return torch.sigmoid(x)
def _layernorm(x, axis=-1, eps=1e-5):
    m = x.mean(dim=axis, keepdim=True)
    v = x.var(dim=axis, keepdim=True, unbiased=False)
    return (x - m) / torch.sqrt(v + eps)
def _scatter_add(tgt, idx, src, axis=0):
    return tgt.clone().index_add_(axis, idx, src)
def _segment_sum(src, seg, n):
    out = torch.zeros((n,) + src.shape[1:], dtype=src.dtype)
    return out.index_add_(0, seg, src)
def _pad(x, pw):
    flat = tuple(v for pair in reversed(pw) for v in pair)
    return torch.nn.functional.pad(x, flat)

kernel_name = 'standalone__gqa_softmax__near_ridge'

def setup_inputs():

    _w = (lambda a: (lambda t: t.to(torch.bfloat16) if t.is_floating_point() else t)(torch.as_tensor(a)))
    B, Hq, Hkv, Sq, Sk, D = 16, 16, 8, 512, 512, 256
    return {
        "q": _w((lambda *s: torch.randn(*s, dtype=torch.bfloat16) * 0.8)(B, Hq, Sq, D)),
        "k": _w((lambda *s: torch.randn(*s, dtype=torch.bfloat16) * 0.8)(B, Hkv, Sk, D)),
        "v": _w((lambda *s: torch.randn(*s, dtype=torch.bfloat16) * 0.05)(B, Hkv, Sk, D)),
    }

def reference(q, k, v):
    B, Hq, Sq, D = q.shape
    Hkv = k.shape[1]
    rep = Hq // Hkv
    k = (lambda x, n, axis: torch.repeat_interleave(x, n, dim=axis))(k, rep, axis=1)
    v = (lambda x, n, axis: torch.repeat_interleave(x, n, dim=axis))(v, rep, axis=1)
    scale = D ** -0.5
    scores = torch.einsum("bhqd,bhkd->bhqk", q, k) * scale
    p = _softmax(scores, axis=-1)
    return torch.einsum("bhqk,bhkd->bhqd", p, v)
```

```asm
; @launch grid=(256,1,1) block=(256,1,1) lds=163840
.amdgcn_target "amdgcn-amd-amdhsa--gfx950"
.text
.globl standalone__gqa_softmax__near_ridge_kernel
.p2align 8
.type standalone__gqa_softmax__near_ridge_kernel,@function
standalone__gqa_softmax__near_ridge_kernel:
    s_cmp_ge_u32 s2, 256
    s_cbranch_scc1 L_end
    s_load_dwordx4 s[4:7], s[0:1], 0
    s_load_dwordx4 s[92:95], s[0:1], 16
    v_lshrrev_b32 v123, 6, v0
    v_and_b32 v120, 63, v0
    v_readfirstlane_b32 s30, v123
    v_lshrrev_b32 v121, 4, v120
    v_and_b32 v122, 15, v120
    s_getpc_b64 s[98:99]
L_pc_0:
    v_lshlrev_b32 v12, 6, v0
    v_min_u32 v12, L_loop0_end-L_pc_0-4, v12
    v_mov_b32 v11, s99
    v_add_co_u32 v10, vcc, s98, v12
    s_nop 1
    v_addc_co_u32 v11, vcc, 0, v11, vcc
    global_load_dword v119, v[10:11], off
    s_and_b32 s50, s2, 7
    s_lshr_b32 s51, s2, 3
    s_lshr_b32 s52, s51, 2
    s_and_b32 s51, s51, 3
    s_lshl_b32 s50, s50, 3
    s_add_u32 s50, s50, s52
    s_lshl_b32 s52, s50, 1
    s_lshr_b32 s53, s51, 1
    s_add_u32 s52, s52, s53
    s_lshl_b32 s52, s52, 18
    s_and_b32 s53, s51, 1
    s_lshl_b32 s53, s53, 17
    s_add_u32 s52, s52, s53
    s_lshl_b32 s53, s30, 15
    s_add_u32 s38, s52, s53
    s_lshl_b32 s50, s50, 18
    s_lshl_b32 s54, s30, 12
    s_add_u32 s34, s54, 0
    s_add_u32 s35, s54, 16384
    s_add_u32 s36, s54, 32768
    s_add_u32 s37, s54, 49152
    s_mul_i32 s45, s30, 24576
    s_add_u32 s45, s45, 65536
    s_sub_u32 s41, s38, s54
    s_mov_b32 s28, 0x3db8aa3b
    s_mov_b32 s29, 0x4e800000
    s_mov_b32 s32, 0
    s_mov_b32 s33, 0
    v_lshrrev_b32 v126, 5, v120
    v_and_b32 v127, 31, v120
    s_lshl_b32 s55, s30, 3
    v_add_u32 v0, s55, v126
    v_and_b32 v1, 15, v0
    v_lshlrev_b32 v0, 9, v0
    v_xor_b32 v123, v127, v1
    v_lshlrev_b32 v123, 4, v123
    v_add_u32 v100, v0, v123
    v_xor_b32 v101, 32, v100
    v_xor_b32 v102, 64, v100
    v_xor_b32 v103, 96, v100
    v_lshlrev_b32 v124, 1, v126
    v_xor_b32 v123, v127, v124
    v_lshlrev_b32 v123, 4, v123
    v_add_u32 v104, v0, v123
    v_xor_b32 v105, 64, v104
    v_xor_b32 v106, 128, v104
    v_xor_b32 v107, 192, v104
    v_mov_b32 v118, v120
    s_waitcnt lgkmcnt(0)
    s_add_u32 s12, s6, s50
    s_addc_u32 s13, s7, 0
    s_mov_b32 s14, 0x1040000
    s_mov_b32 s15, 0x20000
    s_mov_b32 s8, s4
    s_mov_b32 s9, s5
    s_mov_b32 s10, 0x4000000
    s_mov_b32 s11, 0x20000
    v_lshlrev_b32 v123, 9, v122
    v_lshlrev_b32 v124, 4, v121
    v_add_u32 v108, v123, v124
    s_add_u32 s39, s38, 24576
    s_mov_b32 s32, 0
    s_mov_b32 m0, s34
    s_nop 0
    buffer_load_dwordx4 v100, s[12:15], s32 offen lds
    buffer_load_dwordx4 v101, s[12:15], s32 offen offset:1024 lds
    buffer_load_dwordx4 v102, s[12:15], s32 offen offset:2048 lds
    buffer_load_dwordx4 v103, s[12:15], s32 offen offset:3072 lds
    s_add_u32 s56, s45, 0
    s_mov_b32 m0, s56
    s_nop 0
    buffer_load_dwordx4 v100, s[8:11], s41 offen nt lds
    buffer_load_dwordx4 v101, s[8:11], s41 offen offset:1024 nt lds
    buffer_load_dwordx4 v102, s[8:11], s41 offen offset:2048 nt lds
    buffer_load_dwordx4 v103, s[8:11], s41 offen offset:3072 nt lds
    s_add_u32 s41, s41, 4096
    s_add_u32 s56, s45, 4096
    s_mov_b32 m0, s56
    s_nop 0
    buffer_load_dwordx4 v100, s[8:11], s41 offen nt lds
    buffer_load_dwordx4 v101, s[8:11], s41 offen offset:1024 nt lds
    buffer_load_dwordx4 v102, s[8:11], s41 offen offset:2048 nt lds
    buffer_load_dwordx4 v103, s[8:11], s41 offen offset:3072 nt lds
    s_add_u32 s41, s41, 4096
    s_add_u32 s56, s45, 8192
    s_mov_b32 m0, s56
    s_nop 0
    buffer_load_dwordx4 v100, s[8:11], s41 offen nt lds
    buffer_load_dwordx4 v101, s[8:11], s41 offen offset:1024 nt lds
    buffer_load_dwordx4 v102, s[8:11], s41 offen offset:2048 nt lds
    buffer_load_dwordx4 v103, s[8:11], s41 offen offset:3072 nt lds
    s_add_u32 s41, s41, 4096
    s_add_u32 s56, s45, 12288
    s_mov_b32 m0, s56
    s_nop 0
    buffer_load_dwordx4 v100, s[8:11], s41 offen nt lds
    buffer_load_dwordx4 v101, s[8:11], s41 offen offset:1024 nt lds
    buffer_load_dwordx4 v102, s[8:11], s41 offen offset:2048 nt lds
    buffer_load_dwordx4 v103, s[8:11], s41 offen offset:3072 nt lds
    s_add_u32 s41, s41, 4096
    s_add_u32 s56, s45, 16384
    s_mov_b32 m0, s56
    s_nop 0
    buffer_load_dwordx4 v100, s[8:11], s41 offen nt lds
    buffer_load_dwordx4 v101, s[8:11], s41 offen offset:1024 nt lds
    buffer_load_dwordx4 v102, s[8:11], s41 offen offset:2048 nt lds
    buffer_load_dwordx4 v103, s[8:11], s41 offen offset:3072 nt lds
    s_add_u32 s41, s41, 4096
    s_add_u32 s56, s45, 20480
    s_mov_b32 m0, s56
    s_nop 0
    buffer_load_dwordx4 v100, s[8:11], s41 offen nt lds
    buffer_load_dwordx4 v101, s[8:11], s41 offen offset:1024 nt lds
    buffer_load_dwordx4 v102, s[8:11], s41 offen offset:2048 nt lds
    buffer_load_dwordx4 v103, s[8:11], s41 offen offset:3072 nt lds
    s_add_u32 s41, s41, 4096
    buffer_load_dwordx4 a[96:99], v108, s[8:11], s39 offen nt
    buffer_load_dwordx4 a[100:103], v108, s[8:11], s39 offen offset:64 nt
    buffer_load_dwordx4 a[104:107], v108, s[8:11], s39 offen offset:128 nt
    buffer_load_dwordx4 a[108:111], v108, s[8:11], s39 offen offset:192 nt
    buffer_load_dwordx4 a[112:115], v108, s[8:11], s39 offen offset:256 nt
    buffer_load_dwordx4 a[116:119], v108, s[8:11], s39 offen offset:320 nt
    buffer_load_dwordx4 a[120:123], v108, s[8:11], s39 offen offset:384 nt
    buffer_load_dwordx4 a[124:127], v108, s[8:11], s39 offen offset:448 nt
    s_mov_b32 s32, 16384
    s_mov_b32 m0, s35
    s_nop 0
    buffer_load_dwordx4 v100, s[12:15], s32 offen lds
    buffer_load_dwordx4 v101, s[12:15], s32 offen offset:1024 lds
    buffer_load_dwordx4 v102, s[12:15], s32 offen offset:2048 lds
    buffer_load_dwordx4 v103, s[12:15], s32 offen offset:3072 lds
    s_mov_b32 s32, 32768
    s_add_u32 s16, s92, s50
    s_addc_u32 s17, s93, 0
    s_mov_b32 s18, 0x1040000
    s_mov_b32 s19, 0x20000
    s_mov_b32 s20, s94
    s_mov_b32 s21, s95
    s_mov_b32 s22, 0x4000000
    s_mov_b32 s23, 0x20000
    v_and_b32 v124, 1, v121
    v_lshlrev_b32 v124, 5, v124
    v_lshrrev_b32 v125, 1, v121
    v_lshlrev_b32 v125, 4, v125
    v_add_u32 v124, v124, v125
    v_add_u32 v109, v123, v124
    v_and_b32 v125, 7, v122
    v_lshlrev_b32 v125, 4, v125
    v_xor_b32 v125, v125, v124
    v_lshlrev_b32 v124, 7, v122
    v_add_u32 v125, v125, v124
    v_add_u32 v115, s45, v125
    v_xor_b32 v116, 64, v115
    v_lshrrev_b32 v124, 3, v120
    v_and_b32 v125, 7, v120
    v_lshlrev_b32 v117, 9, v124
    v_lshlrev_b32 v1, 4, v125
    v_add_u32 v117, v117, v1
    v_xor_b32 v125, v125, v124
    v_lshlrev_b32 v125, 4, v125
    v_lshlrev_b32 v124, 7, v124
    v_add_u32 v125, v125, v124
    v_add_u32 v114, s45, v125
    v_xor_b32 v124, v121, v122
    v_lshlrev_b32 v124, 4, v124
    v_add_u32 v88, v123, v124
    v_xor_b32 v89, 64, v88
    v_xor_b32 v90, 128, v88
    v_xor_b32 v91, 192, v88
    v_lshrrev_b32 v123, 2, v122
    v_lshlrev_b32 v124, 2, v121
    v_add_u32 v2, v123, v124
    v_and_b32 v3, 3, v120
    v_and_b32 v123, 7, v2
    v_lshlrev_b32 v123, 1, v123
    v_lshrrev_b32 v124, 1, v3
    v_xor_b32 v123, v123, v124
    v_lshlrev_b32 v123, 4, v123
    v_and_b32 v124, 1, v3
    v_lshlrev_b32 v124, 3, v124
    v_add_u32 v123, v123, v124
    v_lshlrev_b32 v124, 9, v2
    v_add_u32 v92, v123, v124
    v_xor_b32 v93, 32, v92
    v_xor_b32 v94, 64, v92
    v_xor_b32 v95, 96, v92
    v_xor_b32 v96, 128, v92
    v_xor_b32 v97, 160, v92
    v_xor_b32 v98, 192, v92
    v_xor_b32 v99, 224, v92
    v_lshrrev_b32 v120, 3, v118
    s_and_b32 s50, s30, 1
    v_xor_b32 v120, s50, v120
    v_and_b32 v120, 1, v120
    v_lshlrev_b32 v120, 7, v120
    v_xor_b32 v110, v120, v88
    v_add_u32 v110, s45, v110
    v_xor_b32 v111, v120, v89
    v_add_u32 v111, s45, v111
    v_xor_b32 v112, v120, v90
    v_add_u32 v112, s45, v112
    v_xor_b32 v113, v120, v91
    v_add_u32 v113, s45, v113
    s_waitcnt vmcnt(12)
    ds_read_b128 a[0:3], v110 offset:0
    ds_read_b128 a[32:35], v110 offset:8192
    ds_read_b128 a[64:67], v110 offset:16384
    ds_read_b128 a[4:7], v111 offset:0
    ds_read_b128 a[36:39], v111 offset:8192
    ds_read_b128 a[68:71], v111 offset:16384
    ds_read_b128 a[8:11], v112 offset:0
    ds_read_b128 a[40:43], v112 offset:8192
    s_waitcnt lgkmcnt(4)
    ds_read_b128 a[72:75], v112 offset:16384
    ds_read_b128 a[12:15], v113 offset:0
    ds_read_b128 a[44:47], v113 offset:8192
    ds_read_b128 a[76:79], v113 offset:16384
    ds_read_b128 a[16:19], v110 offset:256
    ds_read_b128 a[48:51], v110 offset:8448
    ds_read_b128 a[80:83], v110 offset:16640
    ds_read_b128 a[20:23], v111 offset:256
    s_waitcnt lgkmcnt(4)
    ds_read_b128 a[52:55], v111 offset:8448
    ds_read_b128 a[84:87], v111 offset:16640
    ds_read_b128 a[24:27], v112 offset:256
    ds_read_b128 a[56:59], v112 offset:8448
    ds_read_b128 a[88:91], v112 offset:16640
    ds_read_b128 a[28:31], v113 offset:256
    ds_read_b128 a[60:63], v113 offset:8448
    ds_read_b128 a[92:95], v113 offset:16640
    s_waitcnt lgkmcnt(4)
    s_waitcnt vmcnt(36)
    s_barrier
    ds_read_b128 v[64:67], v88 offset:0
    ds_read_b128 v[68:71], v89 offset:0
    ds_read_b128 v[72:75], v90 offset:0
    s_waitcnt vmcnt(11) lgkmcnt(2)
    v_mfma_f32_16x16x32_bf16 v[0:3], v[64:67], a[0:3], 0
    ds_read_b128 v[76:79], v91 offset:0
    v_mfma_f32_16x16x32_bf16 v[4:7], v[64:67], a[32:35], 0
    v_mfma_f32_16x16x32_bf16 v[8:11], v[64:67], a[64:67], 0
    v_mfma_f32_16x16x32_bf16 v[12:15], v[64:67], a[96:99], 0
    s_waitcnt vmcnt(10) lgkmcnt(2)
    v_mfma_f32_16x16x32_bf16 v[0:3], v[68:71], a[4:7], v[0:3]
    ds_read_b128 v[64:67], v88 offset:256
    v_mfma_f32_16x16x32_bf16 v[4:7], v[68:71], a[36:39], v[4:7]
    v_mfma_f32_16x16x32_bf16 v[8:11], v[68:71], a[68:71], v[8:11]
    v_mfma_f32_16x16x32_bf16 v[12:15], v[68:71], a[100:103], v[12:15]
    s_waitcnt vmcnt(9) lgkmcnt(2)
    v_mfma_f32_16x16x32_bf16 v[0:3], v[72:75], a[8:11], v[0:3]
    ds_read_b128 v[68:71], v89 offset:256
    v_mfma_f32_16x16x32_bf16 v[4:7], v[72:75], a[40:43], v[4:7]
    v_mfma_f32_16x16x32_bf16 v[8:11], v[72:75], a[72:75], v[8:11]
    v_mfma_f32_16x16x32_bf16 v[12:15], v[72:75], a[104:107], v[12:15]
    s_waitcnt vmcnt(8) lgkmcnt(2)
    v_mfma_f32_16x16x32_bf16 v[0:3], v[76:79], a[12:15], v[0:3]
    ds_read_b128 v[72:75], v90 offset:256
    v_mfma_f32_16x16x32_bf16 v[4:7], v[76:79], a[44:47], v[4:7]
    v_mfma_f32_16x16x32_bf16 v[8:11], v[76:79], a[76:79], v[8:11]
    v_mfma_f32_16x16x32_bf16 v[12:15], v[76:79], a[108:111], v[12:15]
    s_waitcnt vmcnt(7) lgkmcnt(2)
    v_mfma_f32_16x16x32_bf16 v[0:3], v[64:67], a[16:19], v[0:3]
    ds_read_b128 v[76:79], v91 offset:256
    v_mfma_f32_16x16x32_bf16 v[4:7], v[64:67], a[48:51], v[4:7]
    v_mfma_f32_16x16x32_bf16 v[8:11], v[64:67], a[80:83], v[8:11]
    v_mfma_f32_16x16x32_bf16 v[12:15], v[64:67], a[112:115], v[12:15]
    s_waitcnt vmcnt(6) lgkmcnt(2)
    v_mfma_f32_16x16x32_bf16 v[0:3], v[68:71], a[20:23], v[0:3]
    ds_read_b128 v[64:67], v88 offset:8192
    v_mfma_f32_16x16x32_bf16 v[4:7], v[68:71], a[52:55], v[4:7]
    v_mfma_f32_16x16x32_bf16 v[8:11], v[68:71], a[84:87], v[8:11]
    v_mfma_f32_16x16x32_bf16 v[12:15], v[68:71], a[116:119], v[12:15]
    s_waitcnt vmcnt(5) lgkmcnt(2)
    v_mfma_f32_16x16x32_bf16 v[0:3], v[72:75], a[24:27], v[0:3]
    ds_read_b128 v[68:71], v89 offset:8192
    v_mfma_f32_16x16x32_bf16 v[4:7], v[72:75], a[56:59], v[4:7]
    v_mfma_f32_16x16x32_bf16 v[8:11], v[72:75], a[88:91], v[8:11]
    v_mfma_f32_16x16x32_bf16 v[12:15], v[72:75], a[120:123], v[12:15]
    s_waitcnt vmcnt(4) lgkmcnt(2)
    v_mfma_f32_16x16x32_bf16 v[0:3], v[76:79], a[28:31], v[0:3]
    ds_read_b128 v[72:75], v90 offset:8192
    v_mfma_f32_16x16x32_bf16 v[4:7], v[76:79], a[60:63], v[4:7]
    s_mov_b32 m0, s36
    v_mfma_f32_16x16x32_bf16 v[8:11], v[76:79], a[92:95], v[8:11]
    buffer_load_dwordx4 v104, s[16:19], s33 offen lds
    v_mfma_f32_16x16x32_bf16 v[12:15], v[76:79], a[124:127], v[12:15]
    s_waitcnt lgkmcnt(2)
    v_mfma_f32_16x16x32_bf16 v[16:19], v[64:67], a[0:3], 0
    ds_read_b128 v[76:79], v91 offset:8192
    v_mfma_f32_16x16x32_bf16 v[20:23], v[64:67], a[32:35], 0
    v_mfma_f32_16x16x32_bf16 v[24:27], v[64:67], a[64:67], 0
    buffer_load_dwordx4 v105, s[16:19], s33 offen offset:1024 lds
    v_mfma_f32_16x16x32_bf16 v[28:31], v[64:67], a[96:99], 0
    s_waitcnt lgkmcnt(2)
    v_mfma_f32_16x16x32_bf16 v[16:19], v[68:71], a[4:7], v[16:19]
    ds_read_b128 v[64:67], v88 offset:8448
    v_mfma_f32_16x16x32_bf16 v[20:23], v[68:71], a[36:39], v[20:23]
    v_mfma_f32_16x16x32_bf16 v[24:27], v[68:71], a[68:71], v[24:27]
    buffer_load_dwordx4 v106, s[16:19], s33 offen offset:2048 lds
    v_mfma_f32_16x16x32_bf16 v[28:31], v[68:71], a[100:103], v[28:31]
    s_waitcnt lgkmcnt(2)
    v_mfma_f32_16x16x32_bf16 v[16:19], v[72:75], a[8:11], v[16:19]
    ds_read_b128 v[68:71], v89 offset:8448
    v_mfma_f32_16x16x32_bf16 v[20:23], v[72:75], a[40:43], v[20:23]
    v_mfma_f32_16x16x32_bf16 v[24:27], v[72:75], a[72:75], v[24:27]
    buffer_load_dwordx4 v107, s[16:19], s33 offen offset:3072 lds
    v_mfma_f32_16x16x32_bf16 v[28:31], v[72:75], a[104:107], v[28:31]
    s_waitcnt lgkmcnt(2)
    v_mfma_f32_16x16x32_bf16 v[16:19], v[76:79], a[12:15], v[16:19]
    s_add_u32 s33, s33, 16384
    ds_read_b128 v[72:75], v90 offset:8448
    v_mfma_f32_16x16x32_bf16 v[20:23], v[76:79], a[44:47], v[20:23]
    v_mfma_f32_16x16x32_bf16 v[24:27], v[76:79], a[76:79], v[24:27]
    v_mfma_f32_16x16x32_bf16 v[28:31], v[76:79], a[108:111], v[28:31]
    s_waitcnt lgkmcnt(2)
    v_mfma_f32_16x16x32_bf16 v[16:19], v[64:67], a[16:19], v[16:19]
    ds_read_b128 v[76:79], v91 offset:8448
    v_mfma_f32_16x16x32_bf16 v[20:23], v[64:67], a[48:51], v[20:23]
    v_mfma_f32_16x16x32_bf16 v[24:27], v[64:67], a[80:83], v[24:27]
    v_mfma_f32_16x16x32_bf16 v[28:31], v[64:67], a[112:115], v[28:31]
    s_waitcnt lgkmcnt(2)
    v_mfma_f32_16x16x32_bf16 v[16:19], v[68:71], a[20:23], v[16:19]
    v_mfma_f32_16x16x32_bf16 v[20:23], v[68:71], a[52:55], v[20:23]
    v_mfma_f32_16x16x32_bf16 v[24:27], v[68:71], a[84:87], v[24:27]
    v_mfma_f32_16x16x32_bf16 v[28:31], v[68:71], a[116:119], v[28:31]
    s_waitcnt vmcnt(4) lgkmcnt(0)
    s_barrier
    v_mfma_f32_16x16x32_bf16 v[16:19], v[72:75], a[24:27], v[16:19]
    s_mov_b32 m0, s34
    v_mfma_f32_16x16x32_bf16 v[20:23], v[72:75], a[56:59], v[20:23]
    buffer_load_dwordx4 v100, s[12:15], s32 offen lds
    v_mfma_f32_16x16x32_bf16 v[24:27], v[72:75], a[88:91], v[24:27]
    buffer_load_dwordx4 v101, s[12:15], s32 offen offset:1024 lds
    v_mfma_f32_16x16x32_bf16 v[28:31], v[72:75], a[120:123], v[28:31]
    s_waitcnt lgkmcnt(0)
    buffer_load_dwordx4 v102, s[12:15], s32 offen offset:2048 lds
    v_mfma_f32_16x16x32_bf16 v[16:19], v[76:79], a[28:31], v[16:19]
    buffer_load_dwordx4 v103, s[12:15], s32 offen offset:3072 lds
    v_mfma_f32_16x16x32_bf16 v[20:23], v[76:79], a[60:63], v[20:23]
    v_mfma_f32_16x16x32_bf16 v[24:27], v[76:79], a[92:95], v[24:27]
    s_add_u32 s32, s32, 16384
    v_mfma_f32_16x16x32_bf16 v[28:31], v[76:79], a[124:127], v[28:31]
    ds_read_b128 v[64:67], v88 offset:16384
    ds_read_b128 v[68:71], v89 offset:16384
    s_nop 3
    v_max3_f32 v84, v0, v1, v2
    v_max3_f32 v85, v4, v5, v6
    v_max3_f32 v86, v8, v9, v10
    v_max3_f32 v87, v12, v13, v14
    v_max3_f32 v84, v84, v3, v16
    v_max3_f32 v85, v85, v7, v20
    v_max3_f32 v86, v86, v11, v24
    v_max3_f32 v87, v87, v15, v28
    v_max3_f32 v84, v84, v17, v18
    v_max3_f32 v85, v85, v21, v22
    v_max3_f32 v86, v86, v25, v26
    v_max3_f32 v87, v87, v29, v30
    v_max_f32 v84, v84, v19
    v_max_f32 v85, v85, v23
    v_max_f32 v86, v86, v27
    v_max_f32 v87, v87, v31
    v_mov_b32 v120, v84
    v_mov_b32 v121, v85
    v_mov_b32 v122, v86
    v_mov_b32 v123, v87
    s_nop 1
    v_permlane16_swap_b32 v84, v120
    v_permlane16_swap_b32 v85, v121
    v_permlane16_swap_b32 v86, v122
    v_permlane16_swap_b32 v87, v123
    s_nop 1
    v_max_f32 v84, v84, v120
    v_max_f32 v85, v85, v121
    v_max_f32 v86, v86, v122
    v_max_f32 v87, v87, v123
    v_mov_b32 v120, v84
    v_mov_b32 v121, v85
    v_mov_b32 v122, v86
    v_mov_b32 v123, v87
    s_nop 1
    v_permlane32_swap_b32 v84, v120
    v_permlane32_swap_b32 v85, v121
    v_permlane32_swap_b32 v86, v122
    v_permlane32_swap_b32 v87, v123
    s_nop 1
    v_max_f32 v84, v84, v120
    v_max_f32 v85, v85, v121
    v_max_f32 v86, v86, v122
    v_max_f32 v87, v87, v123
    v_mul_f32 v84, s28, v84
    v_mul_f32 v85, s28, v85
    v_mul_f32 v86, s28, v86
    v_mul_f32 v87, s28, v87
    v_mov_b32 v80, 0
    v_mov_b32 v81, 0
    v_mov_b32 v82, 0
    v_mov_b32 v83, 0
    v_fma_f32 v0, v0, s28, -v84
    v_exp_f32 v0, v0
    s_nop 0
    v_add_f32 v80, v80, v0
    v_fma_f32 v1, v1, s28, -v84
    v_exp_f32 v1, v1
    v_fma_f32 v2, v2, s28, -v84
    v_exp_f32 v2, v2
    v_add_f32 v80, v80, v1
    v_add_f32 v80, v80, v2
    v_fma_f32 v3, v3, s28, -v84
    v_exp_f32 v3, v3
    v_fma_f32 v4, v4, s28, -v85
    v_add_f32 v80, v80, v3
    v_exp_f32 v4, v4
    s_nop 0
    v_add_f32 v81, v81, v4
    v_fma_f32 v7, v7, s28, -v85
    v_fma_f32 v6, v6, s28, -v85
    v_fma_f32 v5, v5, s28, -v85
    v_exp_f32 v5, v5
    v_exp_f32 v6, v6
    v_exp_f32 v7, v7
    v_add_f32 v81, v81, v5
    v_add_f32 v81, v81, v6
    v_add_f32 v81, v81, v7
    v_fma_f32 v8, v8, s28, -v86
    v_exp_f32 v8, v8
    v_fma_f32 v10, v10, s28, -v86
    v_fma_f32 v9, v9, s28, -v86
    v_exp_f32 v9, v9
    v_exp_f32 v10, v10
    v_fma_f32 v12, v12, s28, -v87
    v_fma_f32 v11, v11, s28, -v86
    v_exp_f32 v11, v11
    v_exp_f32 v12, v12
    v_add_f32 v82, v82, v8
    v_fma_f32 v13, v13, s28, -v87
    v_exp_f32 v13, v13
    v_add_f32 v82, v82, v9
    v_fma_f32 v14, v14, s28, -v87
    v_exp_f32 v14, v14
    v_add_f32 v82, v82, v10
    v_add_f32 v82, v82, v11
    v_add_f32 v83, v83, v12
    v_fma_f32 v15, v15, s28, -v87
    v_exp_f32 v15, v15
    v_add_f32 v83, v83, v13
    v_add_f32 v83, v83, v14
    v_add_f32 v83, v83, v15
    v_fma_f32 v16, v16, s28, -v84
    v_exp_f32 v16, v16
    v_fma_f32 v18, v18, s28, -v84
    v_fma_f32 v17, v17, s28, -v84
    v_exp_f32 v17, v17
    v_exp_f32 v18, v18
    v_add_f32 v80, v80, v16
    v_fma_f32 v19, v19, s28, -v84
    v_add_f32 v80, v80, v18
    v_exp_f32 v19, v19
    v_add_f32 v80, v80, v17
    v_fma_f32 v20, v20, s28, -v85
    v_exp_f32 v20, v20
    v_add_f32 v80, v80, v19
    v_fma_f32 v21, v21, s28, -v85
    v_exp_f32 v21, v21
    v_add_f32 v81, v81, v20
    v_add_f32 v81, v81, v21
    v_fma_f32 v23, v23, s28, -v85
    v_fma_f32 v22, v22, s28, -v85
    v_exp_f32 v22, v22
    v_exp_f32 v23, v23
    v_add_f32 v81, v81, v22
    v_add_f32 v81, v81, v23
    v_cvt_pk_bf16_f32 v34, v16, v17
    v_cvt_pk_bf16_f32 v35, v18, v19
    v_cvt_pk_bf16_f32 v32, v0, v1
    v_cvt_pk_bf16_f32 v33, v2, v3
    v_cvt_pk_bf16_f32 v36, v4, v5
    v_cvt_pk_bf16_f32 v37, v6, v7
    s_nop 0
    s_waitcnt lgkmcnt(0)
    s_mov_b32 s40, s38
    s_lshl_b32 s54, s30, 12
    s_add_u32 s41, s38, 33554432
    s_sub_u32 s41, s41, s54
    s_mov_b32 s42, s45
    s_add_u32 s39, s38, 33579008
    v_mfma_f32_16x16x32_bf16 v[0:3], v[64:67], a[0:3], 0
    ds_read_b128 v[72:75], v90 offset:16384
    v_cvt_pk_bf16_f32 v38, v20, v21
    v_mfma_f32_16x16x32_bf16 v[0:3], v[68:71], a[4:7], v[0:3]
    v_cvt_pk_bf16_f32 v40, v8, v9
    v_cvt_pk_bf16_f32 v41, v10, v11
    v_mfma_f32_16x16x32_bf16 v[4:7], v[64:67], a[32:35], 0
    ds_read_b128 v[76:79], v91 offset:16384
    v_cvt_pk_bf16_f32 v39, v22, v23
    v_mfma_f32_16x16x32_bf16 v[4:7], v[68:71], a[36:39], v[4:7]
    v_cvt_pk_bf16_f32 v44, v12, v13
    v_cvt_pk_bf16_f32 v45, v14, v15
    v_mfma_f32_16x16x32_bf16 v[8:11], v[64:67], a[64:67], 0
    s_mov_b32 m0, s37
    v_mfma_f32_16x16x32_bf16 v[8:11], v[68:71], a[68:71], v[8:11]
    v_fma_f32 v24, v24, s28, -v86
    v_mfma_f32_16x16x32_bf16 v[12:15], v[64:67], a[96:99], 0
    buffer_load_dwordx4 v104, s[16:19], s33 offen lds
    v_mfma_f32_16x16x32_bf16 v[12:15], v[68:71], a[100:103], v[12:15]
    s_waitcnt lgkmcnt(0)
    v_exp_f32 v24, v24
    v_mfma_f32_16x16x32_bf16 v[0:3], v[72:75], a[8:11], v[0:3]
    ds_read_b128 v[64:67], v88 offset:16640
    v_fma_f32 v25, v25, s28, -v86
    v_mfma_f32_16x16x32_bf16 v[0:3], v[76:79], a[12:15], v[0:3]
    v_exp_f32 v25, v25
    v_mfma_f32_16x16x32_bf16 v[4:7], v[72:75], a[40:43], v[4:7]
    ds_read_b128 v[68:71], v89 offset:16640
    v_cvt_pk_bf16_f32 v42, v24, v25
    v_mfma_f32_16x16x32_bf16 v[4:7], v[76:79], a[44:47], v[4:7]
    v_fma_f32 v26, v26, s28, -v86
    v_fma_f32 v27, v27, s28, -v86
    v_mfma_f32_16x16x32_bf16 v[8:11], v[72:75], a[72:75], v[8:11]
    v_exp_f32 v26, v26
    v_mfma_f32_16x16x32_bf16 v[8:11], v[76:79], a[76:79], v[8:11]
    v_add_f32 v82, v82, v24
    v_add_f32 v82, v82, v25
    v_mfma_f32_16x16x32_bf16 v[12:15], v[72:75], a[104:107], v[12:15]
    buffer_load_dwordx4 v105, s[16:19], s33 offen offset:1024 lds
    v_mfma_f32_16x16x32_bf16 v[12:15], v[76:79], a[108:111], v[12:15]
    s_waitcnt lgkmcnt(0)
    v_exp_f32 v27, v27
    v_mfma_f32_16x16x32_bf16 v[0:3], v[64:67], a[16:19], v[0:3]
    ds_read_b128 v[72:75], v90 offset:16640
    v_cvt_pk_bf16_f32 v43, v26, v27
    v_mfma_f32_16x16x32_bf16 v[0:3], v[68:71], a[20:23], v[0:3]
    v_add_f32 v82, v82, v26
    v_add_f32 v82, v82, v27
    v_mfma_f32_16x16x32_bf16 v[4:7], v[64:67], a[48:51], v[4:7]
    ds_read_b128 v[76:79], v91 offset:16640
    v_fma_f32 v28, v28, s28, -v87
    v_mfma_f32_16x16x32_bf16 v[4:7], v[68:71], a[52:55], v[4:7]
    v_exp_f32 v28, v28
    v_mfma_f32_16x16x32_bf16 v[8:11], v[64:67], a[80:83], v[8:11]
    v_fma_f32 v29, v29, s28, -v87
    v_add_f32 v83, v83, v28
    v_mfma_f32_16x16x32_bf16 v[8:11], v[68:71], a[84:87], v[8:11]
    v_exp_f32 v29, v29
    v_mfma_f32_16x16x32_bf16 v[12:15], v[64:67], a[112:115], v[12:15]
    buffer_load_dwordx4 v106, s[16:19], s33 offen offset:2048 lds
    v_mfma_f32_16x16x32_bf16 v[12:15], v[68:71], a[116:119], v[12:15]
    s_waitcnt lgkmcnt(0)
    v_add_f32 v83, v83, v29
    v_cvt_pk_bf16_f32 v46, v28, v29
    v_mfma_f32_16x16x32_bf16 v[0:3], v[72:75], a[24:27], v[0:3]
    ds_read_b128 v[64:67], v88 offset:24576
    v_fma_f32 v30, v30, s28, -v87
    v_mfma_f32_16x16x32_bf16 v[0:3], v[76:79], a[28:31], v[0:3]
    v_exp_f32 v30, v30
    v_mfma_f32_16x16x32_bf16 v[4:7], v[72:75], a[56:59], v[4:7]
    ds_read_b128 v[68:71], v89 offset:24576
    v_fma_f32 v31, v31, s28, -v87
    v_mfma_f32_16x16x32_bf16 v[4:7], v[76:79], a[60:63], v[4:7]
    v_exp_f32 v31, v31
    v_mfma_f32_16x16x32_bf16 v[8:11], v[72:75], a[88:91], v[8:11]
    v_add_f32 v83, v83, v30
    v_cvt_pk_bf16_f32 v47, v30, v31
    v_mfma_f32_16x16x32_bf16 v[8:11], v[76:79], a[92:95], v[8:11]
    v_mfma_f32_16x16x32_bf16 v[12:15], v[72:75], a[120:123], v[12:15]
    buffer_load_dwordx4 v107, s[16:19], s33 offen offset:3072 lds
    v_mfma_f32_16x16x32_bf16 v[12:15], v[76:79], a[124:127], v[12:15]
    s_waitcnt lgkmcnt(0)
    v_mfma_f32_16x16x32_bf16 v[16:19], v[64:67], a[0:3], 0
    s_add_u32 s33, s33, 16384
    ds_read_b128 v[72:75], v90 offset:24576
    v_add_f32 v83, v83, v31
    v_mfma_f32_16x16x32_bf16 v[16:19], v[68:71], a[4:7], v[16:19]
    v_mfma_f32_16x16x32_bf16 v[20:23], v[64:67], a[32:35], 0
    ds_read_b128 v[76:79], v91 offset:24576
    v_fma_f32 v0, v0, s28, -v84
    v_mfma_f32_16x16x32_bf16 v[20:23], v[68:71], a[36:39], v[20:23]
    v_mfma_f32_16x16x32_bf16 v[24:27], v[64:67], a[64:67], 0
    v_mfma_f32_16x16x32_bf16 v[24:27], v[68:71], a[68:71], v[24:27]
    v_mfma_f32_16x16x32_bf16 v[28:31], v[64:67], a[96:99], 0
    v_exp_f32 v0, v0
    v_mfma_f32_16x16x32_bf16 v[28:31], v[68:71], a[100:103], v[28:31]
    s_waitcnt lgkmcnt(0)
    v_add_f32 v80, v80, v0
    v_mfma_f32_16x16x32_bf16 v[16:19], v[72:75], a[8:11], v[16:19]
    ds_read_b128 v[64:67], v88 offset:24832
    v_fma_f32 v1, v1, s28, -v84
    v_mfma_f32_16x16x32_bf16 v[16:19], v[76:79], a[12:15], v[16:19]
    v_exp_f32 v1, v1
    v_mfma_f32_16x16x32_bf16 v[20:23], v[72:75], a[40:43], v[20:23]
    ds_read_b128 v[68:71], v89 offset:24832
    v_fma_f32 v2, v2, s28, -v84
    v_mfma_f32_16x16x32_bf16 v[20:23], v[76:79], a[44:47], v[20:23]
    v_mfma_f32_16x16x32_bf16 v[24:27], v[72:75], a[72:75], v[24:27]
    v_mfma_f32_16x16x32_bf16 v[24:27], v[76:79], a[76:79], v[24:27]
    v_exp_f32 v2, v2
    v_mfma_f32_16x16x32_bf16 v[28:31], v[72:75], a[104:107], v[28:31]
    v_add_f32 v80, v80, v1
    v_mfma_f32_16x16x32_bf16 v[28:31], v[76:79], a[108:111], v[28:31]
    s_waitcnt lgkmcnt(0)
    v_add_f32 v80, v80, v2
    v_mfma_f32_16x16x32_bf16 v[16:19], v[64:67], a[16:19], v[16:19]
    ds_read_b128 v[72:75], v90 offset:24832
    v_fma_f32 v3, v3, s28, -v84
    v_mfma_f32_16x16x32_bf16 v[16:19], v[68:71], a[20:23], v[16:19]
    v_exp_f32 v3, v3
    v_mfma_f32_16x16x32_bf16 v[20:23], v[64:67], a[48:51], v[20:23]
    ds_read_b128 v[76:79], v91 offset:24832
    v_fma_f32 v4, v4, s28, -v85
    v_mfma_f32_16x16x32_bf16 v[20:23], v[68:71], a[52:55], v[20:23]
    v_add_f32 v80, v80, v3
    v_mfma_f32_16x16x32_bf16 v[24:27], v[64:67], a[80:83], v[24:27]
    v_mfma_f32_16x16x32_bf16 v[24:27], v[68:71], a[84:87], v[24:27]
    v_exp_f32 v4, v4
    v_mfma_f32_16x16x32_bf16 v[28:31], v[64:67], a[112:115], v[28:31]
    v_mfma_f32_16x16x32_bf16 v[28:31], v[68:71], a[116:119], v[28:31]
    s_waitcnt vmcnt(8) lgkmcnt(0)
    s_barrier
    v_mfma_f32_16x16x32_bf16 v[16:19], v[72:75], a[24:27], v[16:19]
    ds_read_b64_tr_b16 v[64:65], v92 offset:32768
    v_add_f32 v81, v81, v4
    v_mfma_f32_16x16x32_bf16 v[16:19], v[76:79], a[28:31], v[16:19]
    ds_read_b64_tr_b16 v[66:67], v92 offset:40960
    v_fma_f32 v7, v7, s28, -v85
    v_mfma_f32_16x16x32_bf16 v[20:23], v[72:75], a[56:59], v[20:23]
    ds_read_b64_tr_b16 v[68:69], v93 offset:32768
    v_fma_f32 v6, v6, s28, -v85
    v_mfma_f32_16x16x32_bf16 v[20:23], v[76:79], a[60:63], v[20:23]
    ds_read_b64_tr_b16 v[70:71], v93 offset:40960
    v_fma_f32 v5, v5, s28, -v85
    v_mfma_f32_16x16x32_bf16 v[24:27], v[72:75], a[88:91], v[24:27]
    v_exp_f32 v5, v5
    v_mfma_f32_16x16x32_bf16 v[24:27], v[76:79], a[92:95], v[24:27]
    v_exp_f32 v6, v6
    v_mfma_f32_16x16x32_bf16 v[28:31], v[72:75], a[120:123], v[28:31]
    v_mfma_f32_16x16x32_bf16 v[28:31], v[76:79], a[124:127], v[28:31]
    s_waitcnt lgkmcnt(2)
    v_exp_f32 v7, v7
    v_mfma_f32_16x16x32_bf16 v[128:131], v[64:67], v[32:35], 0
    ds_read_b64_tr_b16 v[72:73], v94 offset:32768
    v_add_f32 v81, v81, v5
    v_mfma_f32_16x16x32_bf16 v[132:135], v[64:67], v[36:39], 0
    ds_read_b64_tr_b16 v[74:75], v94 offset:40960
    v_add_f32 v81, v81, v6
    v_mfma_f32_16x16x32_bf16 v[136:139], v[64:67], v[40:43], 0
    ds_read_b64_tr_b16 v[76:77], v95 offset:32768
    v_add_f32 v81, v81, v7
    v_mfma_f32_16x16x32_bf16 v[140:143], v[64:67], v[44:47], 0
    s_waitcnt lgkmcnt(3)
    ds_read_b64_tr_b16 v[78:79], v95 offset:40960
    v_mfma_f32_16x16x32_bf16 v[144:147], v[68:71], v[32:35], 0
    s_mov_b32 m0, s35
    ds_read_b64_tr_b16 v[64:65], v96 offset:32768
    v_mfma_f32_16x16x32_bf16 v[148:151], v[68:71], v[36:39], 0
    ds_read_b64_tr_b16 v[66:67], v96 offset:40960
    v_fma_f32 v8, v8, s28, -v86
    v_mfma_f32_16x16x32_bf16 v[152:155], v[68:71], v[40:43], 0
    buffer_load_dwordx4 v100, s[12:15], s32 offen lds
    v_mfma_f32_16x16x32_bf16 v[156:159], v[68:71], v[44:47], 0
    s_waitcnt lgkmcnt(4)
    v_exp_f32 v8, v8
    v_mfma_f32_16x16x32_bf16 v[160:163], v[72:75], v[32:35], 0
    ds_read_b64_tr_b16 v[68:69], v97 offset:32768
    v_fma_f32 v10, v10, s28, -v86
    v_mfma_f32_16x16x32_bf16 v[164:167], v[72:75], v[36:39], 0
    ds_read_b64_tr_b16 v[70:71], v97 offset:40960
    v_fma_f32 v9, v9, s28, -v86
    v_mfma_f32_16x16x32_bf16 v[168:171], v[72:75], v[40:43], 0
    v_exp_f32 v9, v9
    v_mfma_f32_16x16x32_bf16 v[172:175], v[72:75], v[44:47], 0
    s_waitcnt lgkmcnt(4)
    v_exp_f32 v10, v10
    v_mfma_f32_16x16x32_bf16 v[176:179], v[76:79], v[32:35], 0
    ds_read_b64_tr_b16 v[72:73], v98 offset:32768
    v_fma_f32 v12, v12, s28, -v87
    v_mfma_f32_16x16x32_bf16 v[180:183], v[76:79], v[36:39], 0
    ds_read_b64_tr_b16 v[74:75], v98 offset:40960
    v_fma_f32 v11, v11, s28, -v86
    v_mfma_f32_16x16x32_bf16 v[184:187], v[76:79], v[40:43], 0
    v_exp_f32 v11, v11
    v_mfma_f32_16x16x32_bf16 v[188:191], v[76:79], v[44:47], 0
    s_waitcnt lgkmcnt(4)
    v_exp_f32 v12, v12
    v_mfma_f32_16x16x32_bf16 v[192:195], v[64:67], v[32:35], 0
    ds_read_b64_tr_b16 v[76:77], v99 offset:32768
    v_add_f32 v82, v82, v8
    v_mfma_f32_16x16x32_bf16 v[196:199], v[64:67], v[36:39], 0
    ds_read_b64_tr_b16 v[78:79], v99 offset:40960
    v_fma_f32 v13, v13, s28, -v87
    v_mfma_f32_16x16x32_bf16 v[200:203], v[64:67], v[40:43], 0
    buffer_load_dwordx4 v101, s[12:15], s32 offen offset:1024 lds
    v_mfma_f32_16x16x32_bf16 v[204:207], v[64:67], v[44:47], 0
    s_waitcnt lgkmcnt(4)
    v_exp_f32 v13, v13
    v_mfma_f32_16x16x32_bf16 v[208:211], v[68:71], v[32:35], 0
    ds_read_b64_tr_b16 v[64:65], v92 offset:33024
    v_add_f32 v82, v82, v9
    v_mfma_f32_16x16x32_bf16 v[212:215], v[68:71], v[36:39], 0
    ds_read_b64_tr_b16 v[66:67], v92 offset:41216
    v_fma_f32 v14, v14, s28, -v87
    v_mfma_f32_16x16x32_bf16 v[216:219], v[68:71], v[40:43], 0
    v_exp_f32 v14, v14
    v_mfma_f32_16x16x32_bf16 v[220:223], v[68:71], v[44:47], 0
    s_waitcnt lgkmcnt(4)
    v_add_f32 v82, v82, v10
    v_add_f32 v82, v82, v11
    v_mfma_f32_16x16x32_bf16 v[224:227], v[72:75], v[32:35], 0
    ds_read_b64_tr_b16 v[68:69], v93 offset:33024
    v_add_f32 v83, v83, v12
    v_mfma_f32_16x16x32_bf16 v[228:231], v[72:75], v[36:39], 0
    ds_read_b64_tr_b16 v[70:71], v93 offset:41216
    v_fma_f32 v15, v15, s28, -v87
    v_mfma_f32_16x16x32_bf16 v[232:235], v[72:75], v[40:43], 0
    v_exp_f32 v15, v15
    v_mfma_f32_16x16x32_bf16 v[236:239], v[72:75], v[44:47], 0
    s_waitcnt lgkmcnt(4)
    v_add_f32 v83, v83, v13
    v_add_f32 v83, v83, v14
    v_mfma_f32_16x16x32_bf16 v[240:243], v[76:79], v[32:35], 0
    ds_read_b64_tr_b16 v[72:73], v94 offset:33024
    v_add_f32 v83, v83, v15
    v_mfma_f32_16x16x32_bf16 v[244:247], v[76:79], v[36:39], 0
    ds_read_b64_tr_b16 v[74:75], v94 offset:41216
    v_fma_f32 v16, v16, s28, -v84
    v_mfma_f32_16x16x32_bf16 v[248:251], v[76:79], v[40:43], 0
    buffer_load_dwordx4 v102, s[12:15], s32 offen offset:2048 lds
    v_mfma_f32_16x16x32_bf16 v[252:255], v[76:79], v[44:47], 0
    s_waitcnt lgkmcnt(4)
    v_exp_f32 v16, v16
    v_mfma_f32_16x16x32_bf16 a[128:131], v[64:67], v[32:35], 0
    ds_read_b64_tr_b16 v[76:77], v95 offset:33024
    v_fma_f32 v18, v18, s28, -v84
    v_mfma_f32_16x16x32_bf16 a[132:135], v[64:67], v[36:39], 0
    ds_read_b64_tr_b16 v[78:79], v95 offset:41216
    v_fma_f32 v17, v17, s28, -v84
    v_mfma_f32_16x16x32_bf16 a[136:139], v[64:67], v[40:43], 0
    v_exp_f32 v17, v17
    v_mfma_f32_16x16x32_bf16 a[140:143], v[64:67], v[44:47], 0
    s_waitcnt lgkmcnt(4)
    v_exp_f32 v18, v18
    v_mfma_f32_16x16x32_bf16 a[144:147], v[68:71], v[32:35], 0
    ds_read_b64_tr_b16 v[64:65], v96 offset:33024
    v_add_f32 v80, v80, v16
    v_mfma_f32_16x16x32_bf16 a[148:151], v[68:71], v[36:39], 0
    ds_read_b64_tr_b16 v[66:67], v96 offset:41216
    v_fma_f32 v19, v19, s28, -v84
    v_mfma_f32_16x16x32_bf16 a[152:155], v[68:71], v[40:43], 0
    v_add_f32 v80, v80, v18
    v_mfma_f32_16x16x32_bf16 a[156:159], v[68:71], v[44:47], 0
    s_waitcnt lgkmcnt(4)
    v_exp_f32 v19, v19
    v_mfma_f32_16x16x32_bf16 a[160:163], v[72:75], v[32:35], 0
    ds_read_b64_tr_b16 v[68:69], v97 offset:33024
    v_add_f32 v80, v80, v17
    v_mfma_f32_16x16x32_bf16 a[164:167], v[72:75], v[36:39], 0
    ds_read_b64_tr_b16 v[70:71], v97 offset:41216
    v_fma_f32 v20, v20, s28, -v85
    v_mfma_f32_16x16x32_bf16 a[168:171], v[72:75], v[40:43], 0
    buffer_load_dwordx4 v103, s[12:15], s32 offen offset:3072 lds
    v_mfma_f32_16x16x32_bf16 a[172:175], v[72:75], v[44:47], 0
    s_waitcnt lgkmcnt(4)
    v_exp_f32 v20, v20
    v_mfma_f32_16x16x32_bf16 a[176:179], v[76:79], v[32:35], 0
    s_add_u32 s32, s32, 16384
    ds_read_b64_tr_b16 v[72:73], v98 offset:33024
    v_add_f32 v80, v80, v19
    v_mfma_f32_16x16x32_bf16 a[180:183], v[76:79], v[36:39], 0
    ds_read_b64_tr_b16 v[74:75], v98 offset:41216
    v_fma_f32 v21, v21, s28, -v85
    v_mfma_f32_16x16x32_bf16 a[184:187], v[76:79], v[40:43], 0
    v_exp_f32 v21, v21
    v_mfma_f32_16x16x32_bf16 a[188:191], v[76:79], v[44:47], 0
    s_waitcnt lgkmcnt(4)
    v_add_f32 v81, v81, v20
    v_add_f32 v81, v81, v21
    v_mfma_f32_16x16x32_bf16 a[192:195], v[64:67], v[32:35], 0
    ds_read_b64_tr_b16 v[76:77], v99 offset:33024
    v_fma_f32 v23, v23, s28, -v85
    v_mfma_f32_16x16x32_bf16 a[196:199], v[64:67], v[36:39], 0
    ds_read_b64_tr_b16 v[78:79], v99 offset:41216
    v_fma_f32 v22, v22, s28, -v85
    v_mfma_f32_16x16x32_bf16 a[200:203], v[64:67], v[40:43], 0
    v_exp_f32 v22, v22
    v_mfma_f32_16x16x32_bf16 a[204:207], v[64:67], v[44:47], 0
    s_waitcnt lgkmcnt(4)
    v_mfma_f32_16x16x32_bf16 a[208:211], v[68:71], v[32:35], 0
    v_exp_f32 v23, v23
    v_mfma_f32_16x16x32_bf16 a[212:215], v[68:71], v[36:39], 0
    v_mfma_f32_16x16x32_bf16 a[216:219], v[68:71], v[40:43], 0
    v_mfma_f32_16x16x32_bf16 a[220:223], v[68:71], v[44:47], 0
    s_waitcnt vmcnt(8) lgkmcnt(0)
    s_barrier
    v_mfma_f32_16x16x32_bf16 a[224:227], v[72:75], v[32:35], 0
    ds_read_b128 v[64:67], v88 offset:0
    v_add_f32 v81, v81, v22
    v_mfma_f32_16x16x32_bf16 a[228:231], v[72:75], v[36:39], 0
    ds_read_b128 v[68:71], v89 offset:0
    v_add_f32 v81, v81, v23
    v_mfma_f32_16x16x32_bf16 a[232:235], v[72:75], v[40:43], 0
    v_mfma_f32_16x16x32_bf16 a[236:239], v[72:75], v[44:47], 0
    s_waitcnt lgkmcnt(2)
    v_mfma_f32_16x16x32_bf16 a[240:243], v[76:79], v[32:35], 0
    v_cvt_pk_bf16_f32 v34, v16, v17
    v_cvt_pk_bf16_f32 v35, v18, v19
    v_mfma_f32_16x16x32_bf16 a[244:247], v[76:79], v[36:39], 0
    v_cvt_pk_bf16_f32 v32, v0, v1
    v_cvt_pk_bf16_f32 v33, v2, v3
    v_mfma_f32_16x16x32_bf16 a[248:251], v[76:79], v[40:43], 0
    v_cvt_pk_bf16_f32 v36, v4, v5
    v_cvt_pk_bf16_f32 v37, v6, v7
    v_mfma_f32_16x16x32_bf16 a[252:255], v[76:79], v[44:47], 0
    s_waitcnt lgkmcnt(0)
    s_mov_b32 s46, 7
    .p2align 6
L_loop0:
    v_mfma_f32_16x16x32_bf16 v[0:3], v[64:67], a[0:3], 0
    ds_read_b128 v[72:75], v90 offset:0
    v_cvt_pk_bf16_f32 v38, v20, v21
    v_mfma_f32_16x16x32_bf16 v[0:3], v[68:71], a[4:7], v[0:3]
    v_cvt_pk_bf16_f32 v40, v8, v9
    v_cvt_pk_bf16_f32 v41, v10, v11
    v_mfma_f32_16x16x32_bf16 v[4:7], v[64:67], a[32:35], 0
    ds_read_b128 v[76:79], v91 offset:0
    v_cvt_pk_bf16_f32 v39, v22, v23
    v_mfma_f32_16x16x32_bf16 v[4:7], v[68:71], a[36:39], v[4:7]
    v_cvt_pk_bf16_f32 v44, v12, v13
    v_cvt_pk_bf16_f32 v45, v14, v15
    v_mfma_f32_16x16x32_bf16 v[8:11], v[64:67], a[64:67], 0
    s_mov_b32 m0, s36
    v_mfma_f32_16x16x32_bf16 v[8:11], v[68:71], a[68:71], v[8:11]
    v_fma_f32 v24, v24, s28, -v86
    v_mfma_f32_16x16x32_bf16 v[12:15], v[64:67], a[96:99], 0
    buffer_load_dwordx4 v104, s[16:19], s33 offen lds
    v_mfma_f32_16x16x32_bf16 v[12:15], v[68:71], a[100:103], v[12:15]
    s_waitcnt lgkmcnt(0)
    v_exp_f32 v24, v24
    v_mfma_f32_16x16x32_bf16 v[0:3], v[72:75], a[8:11], v[0:3]
    ds_read_b128 v[64:67], v88 offset:256
    v_fma_f32 v25, v25, s28, -v86
    v_mfma_f32_16x16x32_bf16 v[0:3], v[76:79], a[12:15], v[0:3]
    v_exp_f32 v25, v25
    v_mfma_f32_16x16x32_bf16 v[4:7], v[72:75], a[40:43], v[4:7]
    ds_read_b128 v[68:71], v89 offset:256
    v_cvt_pk_bf16_f32 v42, v24, v25
    v_mfma_f32_16x16x32_bf16 v[4:7], v[76:79], a[44:47], v[4:7]
    v_fma_f32 v26, v26, s28, -v86
    v_fma_f32 v27, v27, s28, -v86
    v_mfma_f32_16x16x32_bf16 v[8:11], v[72:75], a[72:75], v[8:11]
    v_exp_f32 v26, v26
    v_mfma_f32_16x16x32_bf16 v[8:11], v[76:79], a[76:79], v[8:11]
    v_add_f32 v82, v82, v24
    v_add_f32 v82, v82, v25
    v_mfma_f32_16x16x32_bf16 v[12:15], v[72:75], a[104:107], v[12:15]
    buffer_load_dwordx4 v105, s[16:19], s33 offen offset:1024 lds
    v_mfma_f32_16x16x32_bf16 v[12:15], v[76:79], a[108:111], v[12:15]
    s_waitcnt lgkmcnt(0)
    v_exp_f32 v27, v27
    v_mfma_f32_16x16x32_bf16 v[0:3], v[64:67], a[16:19], v[0:3]
    ds_read_b128 v[72:75], v90 offset:256
    v_cvt_pk_bf16_f32 v43, v26, v27
    v_mfma_f32_16x16x32_bf16 v[0:3], v[68:71], a[20:23], v[0:3]
    v_add_f32 v82, v82, v26
    v_add_f32 v82, v82, v27
    v_mfma_f32_16x16x32_bf16 v[4:7], v[64:67], a[48:51], v[4:7]
    ds_read_b128 v[76:79], v91 offset:256
    v_fma_f32 v28, v28, s28, -v87
    v_mfma_f32_16x16x32_bf16 v[4:7], v[68:71], a[52:55], v[4:7]
    v_exp_f32 v28, v28
    v_mfma_f32_16x16x32_bf16 v[8:11], v[64:67], a[80:83], v[8:11]
    v_fma_f32 v29, v29, s28, -v87
    v_add_f32 v83, v83, v28
    v_mfma_f32_16x16x32_bf16 v[8:11], v[68:71], a[84:87], v[8:11]
    v_exp_f32 v29, v29
    v_mfma_f32_16x16x32_bf16 v[12:15], v[64:67], a[112:115], v[12:15]
    buffer_load_dwordx4 v106, s[16:19], s33 offen offset:2048 lds
    v_mfma_f32_16x16x32_bf16 v[12:15], v[68:71], a[116:119], v[12:15]
    s_waitcnt lgkmcnt(0)
    v_add_f32 v83, v83, v29
    v_cvt_pk_bf16_f32 v46, v28, v29
    v_mfma_f32_16x16x32_bf16 v[0:3], v[72:75], a[24:27], v[0:3]
    s_cmp_eq_u32 s46, 1
    ds_read_b128 v[64:67], v88 offset:8192
    v_fma_f32 v30, v30, s28, -v87
    v_mfma_f32_16x16x32_bf16 v[0:3], v[76:79], a[28:31], v[0:3]
    s_cselect_b32 s41, 0x4000000, s41
    v_exp_f32 v30, v30
    v_mfma_f32_16x16x32_bf16 v[4:7], v[72:75], a[56:59], v[4:7]
    s_cselect_b32 s42, 0x3f000, s42
    ds_read_b128 v[68:71], v89 offset:8192
    v_fma_f32 v31, v31, s28, -v87
    v_mfma_f32_16x16x32_bf16 v[4:7], v[76:79], a[60:63], v[4:7]
    v_exp_f32 v31, v31
    v_mfma_f32_16x16x32_bf16 v[8:11], v[72:75], a[88:91], v[8:11]
    v_add_f32 v83, v83, v30
    v_cvt_pk_bf16_f32 v47, v30, v31
    v_mfma_f32_16x16x32_bf16 v[8:11], v[76:79], a[92:95], v[8:11]
    v_mfma_f32_16x16x32_bf16 v[12:15], v[72:75], a[120:123], v[12:15]
    buffer_load_dwordx4 v107, s[16:19], s33 offen offset:3072 lds
    v_mfma_f32_16x16x32_bf16 v[12:15], v[76:79], a[124:127], v[12:15]
    s_waitcnt lgkmcnt(0)
    v_mfma_f32_16x16x32_bf16 v[16:19], v[64:67], a[0:3], 0
    s_add_u32 s33, s33, 16384
    ds_read_b128 v[72:75], v90 offset:8192
    v_add_f32 v83, v83, v31
    v_mfma_f32_16x16x32_bf16 v[16:19], v[68:71], a[4:7], v[16:19]
    s_mov_b32 m0, s42
    v_mfma_f32_16x16x32_bf16 v[20:23], v[64:67], a[32:35], 0
    ds_read_b128 v[76:79], v91 offset:8192
    v_fma_f32 v0, v0, s28, -v84
    v_mfma_f32_16x16x32_bf16 v[20:23], v[68:71], a[36:39], v[20:23]
    v_mfma_f32_16x16x32_bf16 v[24:27], v[64:67], a[64:67], 0
    buffer_load_dwordx4 v100, s[8:11], s41 offen nt lds
    v_mfma_f32_16x16x32_bf16 v[24:27], v[68:71], a[68:71], v[24:27]
    v_mfma_f32_16x16x32_bf16 v[28:31], v[64:67], a[96:99], 0
    v_exp_f32 v0, v0
    v_mfma_f32_16x16x32_bf16 v[28:31], v[68:71], a[100:103], v[28:31]
    s_waitcnt lgkmcnt(0)
    v_add_f32 v80, v80, v0
    v_mfma_f32_16x16x32_bf16 v[16:19], v[72:75], a[8:11], v[16:19]
    ds_read_b128 v[64:67], v88 offset:8448
    v_fma_f32 v1, v1, s28, -v84
    v_mfma_f32_16x16x32_bf16 v[16:19], v[76:79], a[12:15], v[16:19]
    v_exp_f32 v1, v1
    v_mfma_f32_16x16x32_bf16 v[20:23], v[72:75], a[40:43], v[20:23]
    ds_read_b128 v[68:71], v89 offset:8448
    v_fma_f32 v2, v2, s28, -v84
    v_mfma_f32_16x16x32_bf16 v[20:23], v[76:79], a[44:47], v[20:23]
    v_mfma_f32_16x16x32_bf16 v[24:27], v[72:75], a[72:75], v[24:27]
    buffer_load_dwordx4 v101, s[8:11], s41 offen offset:1024 nt lds
    v_mfma_f32_16x16x32_bf16 v[24:27], v[76:79], a[76:79], v[24:27]
    v_exp_f32 v2, v2
    v_mfma_f32_16x16x32_bf16 v[28:31], v[72:75], a[104:107], v[28:31]
    v_add_f32 v80, v80, v1
    v_mfma_f32_16x16x32_bf16 v[28:31], v[76:79], a[108:111], v[28:31]
    s_waitcnt lgkmcnt(0)
    v_add_f32 v80, v80, v2
    v_mfma_f32_16x16x32_bf16 v[16:19], v[64:67], a[16:19], v[16:19]
    ds_read_b128 v[72:75], v90 offset:8448
    v_fma_f32 v3, v3, s28, -v84
    v_mfma_f32_16x16x32_bf16 v[16:19], v[68:71], a[20:23], v[16:19]
    v_exp_f32 v3, v3
    v_mfma_f32_16x16x32_bf16 v[20:23], v[64:67], a[48:51], v[20:23]
    ds_read_b128 v[76:79], v91 offset:8448
    v_fma_f32 v4, v4, s28, -v85
    v_mfma_f32_16x16x32_bf16 v[20:23], v[68:71], a[52:55], v[20:23]
    v_add_f32 v80, v80, v3
    v_mfma_f32_16x16x32_bf16 v[24:27], v[64:67], a[80:83], v[24:27]
    v_mfma_f32_16x16x32_bf16 v[24:27], v[68:71], a[84:87], v[24:27]
    v_exp_f32 v4, v4
    v_mfma_f32_16x16x32_bf16 v[28:31], v[64:67], a[112:115], v[28:31]
    v_mfma_f32_16x16x32_bf16 v[28:31], v[68:71], a[116:119], v[28:31]
    s_waitcnt vmcnt(10) lgkmcnt(0)
    s_barrier
    v_mfma_f32_16x16x32_bf16 v[16:19], v[72:75], a[24:27], v[16:19]
    ds_read_b64_tr_b16 v[64:65], v92 offset:49152
    v_add_f32 v81, v81, v4
    v_mfma_f32_16x16x32_bf16 v[16:19], v[76:79], a[28:31], v[16:19]
    ds_read_b64_tr_b16 v[66:67], v92 offset:57344
    v_fma_f32 v7, v7, s28, -v85
    v_mfma_f32_16x16x32_bf16 v[20:23], v[72:75], a[56:59], v[20:23]
    ds_read_b64_tr_b16 v[68:69], v93 offset:49152
    v_fma_f32 v6, v6, s28, -v85
    v_mfma_f32_16x16x32_bf16 v[20:23], v[76:79], a[60:63], v[20:23]
    ds_read_b64_tr_b16 v[70:71], v93 offset:57344
    v_fma_f32 v5, v5, s28, -v85
    v_mfma_f32_16x16x32_bf16 v[24:27], v[72:75], a[88:91], v[24:27]
    v_exp_f32 v5, v5
    v_mfma_f32_16x16x32_bf16 v[24:27], v[76:79], a[92:95], v[24:27]
    v_exp_f32 v6, v6
    v_mfma_f32_16x16x32_bf16 v[28:31], v[72:75], a[120:123], v[28:31]
    v_mfma_f32_16x16x32_bf16 v[28:31], v[76:79], a[124:127], v[28:31]
    s_waitcnt lgkmcnt(2)
    v_exp_f32 v7, v7
    v_mfma_f32_16x16x32_bf16 v[128:131], v[64:67], v[32:35], v[128:131]
    ds_read_b64_tr_b16 v[72:73], v94 offset:49152
    v_add_f32 v81, v81, v5
    v_mfma_f32_16x16x32_bf16 v[132:135], v[64:67], v[36:39], v[132:135]
    ds_read_b64_tr_b16 v[74:75], v94 offset:57344
    v_add_f32 v81, v81, v6
    v_mfma_f32_16x16x32_bf16 v[136:139], v[64:67], v[40:43], v[136:139]
    ds_read_b64_tr_b16 v[76:77], v95 offset:49152
    v_add_f32 v81, v81, v7
    v_mfma_f32_16x16x32_bf16 v[140:143], v[64:67], v[44:47], v[140:143]
    s_waitcnt lgkmcnt(3)
    ds_read_b64_tr_b16 v[78:79], v95 offset:57344
    v_mfma_f32_16x16x32_bf16 v[144:147], v[68:71], v[32:35], v[144:147]
    s_mov_b32 m0, s34
    ds_read_b64_tr_b16 v[64:65], v96 offset:49152
    v_mfma_f32_16x16x32_bf16 v[148:151], v[68:71], v[36:39], v[148:151]
    ds_read_b64_tr_b16 v[66:67], v96 offset:57344
    v_fma_f32 v8, v8, s28, -v86
    v_mfma_f32_16x16x32_bf16 v[152:155], v[68:71], v[40:43], v[152:155]
    buffer_load_dwordx4 v100, s[12:15], s32 offen lds
    v_mfma_f32_16x16x32_bf16 v[156:159], v[68:71], v[44:47], v[156:159]
    s_waitcnt lgkmcnt(4)
    v_exp_f32 v8, v8
    v_mfma_f32_16x16x32_bf16 v[160:163], v[72:75], v[32:35], v[160:163]
    ds_read_b64_tr_b16 v[68:69], v97 offset:49152
    v_fma_f32 v10, v10, s28, -v86
    v_mfma_f32_16x16x32_bf16 v[164:167], v[72:75], v[36:39], v[164:167]
    ds_read_b64_tr_b16 v[70:71], v97 offset:57344
    v_fma_f32 v9, v9, s28, -v86
    v_mfma_f32_16x16x32_bf16 v[168:171], v[72:75], v[40:43], v[168:171]
    v_exp_f32 v9, v9
    v_mfma_f32_16x16x32_bf16 v[172:175], v[72:75], v[44:47], v[172:175]
    s_waitcnt lgkmcnt(4)
    v_exp_f32 v10, v10
    v_mfma_f32_16x16x32_bf16 v[176:179], v[76:79], v[32:35], v[176:179]
    ds_read_b64_tr_b16 v[72:73], v98 offset:49152
    v_fma_f32 v12, v12, s28, -v87
    v_mfma_f32_16x16x32_bf16 v[180:183], v[76:79], v[36:39], v[180:183]
    ds_read_b64_tr_b16 v[74:75], v98 offset:57344
    v_fma_f32 v11, v11, s28, -v86
    v_mfma_f32_16x16x32_bf16 v[184:187], v[76:79], v[40:43], v[184:187]
    v_exp_f32 v11, v11
    v_mfma_f32_16x16x32_bf16 v[188:191], v[76:79], v[44:47], v[188:191]
    s_waitcnt lgkmcnt(4)
    v_exp_f32 v12, v12
    v_mfma_f32_16x16x32_bf16 v[192:195], v[64:67], v[32:35], v[192:195]
    ds_read_b64_tr_b16 v[76:77], v99 offset:49152
    v_add_f32 v82, v82, v8
    v_mfma_f32_16x16x32_bf16 v[196:199], v[64:67], v[36:39], v[196:199]
    ds_read_b64_tr_b16 v[78:79], v99 offset:57344
    v_fma_f32 v13, v13, s28, -v87
    v_mfma_f32_16x16x32_bf16 v[200:203], v[64:67], v[40:43], v[200:203]
    buffer_load_dwordx4 v101, s[12:15], s32 offen offset:1024 lds
    v_mfma_f32_16x16x32_bf16 v[204:207], v[64:67], v[44:47], v[204:207]
    s_waitcnt lgkmcnt(4)
    v_exp_f32 v13, v13
    v_mfma_f32_16x16x32_bf16 v[208:211], v[68:71], v[32:35], v[208:211]
    ds_read_b64_tr_b16 v[64:65], v92 offset:49408
    v_add_f32 v82, v82, v9
    v_mfma_f32_16x16x32_bf16 v[212:215], v[68:71], v[36:39], v[212:215]
    ds_read_b64_tr_b16 v[66:67], v92 offset:57600
    v_fma_f32 v14, v14, s28, -v87
    v_mfma_f32_16x16x32_bf16 v[216:219], v[68:71], v[40:43], v[216:219]
    v_exp_f32 v14, v14
    v_mfma_f32_16x16x32_bf16 v[220:223], v[68:71], v[44:47], v[220:223]
    s_waitcnt lgkmcnt(4)
    v_add_f32 v82, v82, v10
    v_add_f32 v82, v82, v11
    v_mfma_f32_16x16x32_bf16 v[224:227], v[72:75], v[32:35], v[224:227]
    ds_read_b64_tr_b16 v[68:69], v93 offset:49408
    v_add_f32 v83, v83, v12
    v_mfma_f32_16x16x32_bf16 v[228:231], v[72:75], v[36:39], v[228:231]
    ds_read_b64_tr_b16 v[70:71], v93 offset:57600
    v_fma_f32 v15, v15, s28, -v87
    v_mfma_f32_16x16x32_bf16 v[232:235], v[72:75], v[40:43], v[232:235]
    v_exp_f32 v15, v15
    v_mfma_f32_16x16x32_bf16 v[236:239], v[72:75], v[44:47], v[236:239]
    s_waitcnt lgkmcnt(4)
    v_add_f32 v83, v83, v13
    v_add_f32 v83, v83, v14
    v_mfma_f32_16x16x32_bf16 v[240:243], v[76:79], v[32:35], v[240:243]
    ds_read_b64_tr_b16 v[72:73], v94 offset:49408
    v_add_f32 v83, v83, v15
    v_mfma_f32_16x16x32_bf16 v[244:247], v[76:79], v[36:39], v[244:247]
    ds_read_b64_tr_b16 v[74:75], v94 offset:57600
    v_fma_f32 v16, v16, s28, -v84
    v_mfma_f32_16x16x32_bf16 v[248:251], v[76:79], v[40:43], v[248:251]
    buffer_load_dwordx4 v102, s[12:15], s32 offen offset:2048 lds
    v_mfma_f32_16x16x32_bf16 v[252:255], v[76:79], v[44:47], v[252:255]
    s_waitcnt lgkmcnt(4)
    v_exp_f32 v16, v16
    v_mfma_f32_16x16x32_bf16 a[128:131], v[64:67], v[32:35], a[128:131]
    ds_read_b64_tr_b16 v[76:77], v95 offset:49408
    v_fma_f32 v18, v18, s28, -v84
    v_mfma_f32_16x16x32_bf16 a[132:135], v[64:67], v[36:39], a[132:135]
    ds_read_b64_tr_b16 v[78:79], v95 offset:57600
    v_fma_f32 v17, v17, s28, -v84
    v_mfma_f32_16x16x32_bf16 a[136:139], v[64:67], v[40:43], a[136:139]
    v_exp_f32 v17, v17
    v_mfma_f32_16x16x32_bf16 a[140:143], v[64:67], v[44:47], a[140:143]
    s_waitcnt lgkmcnt(4)
    v_exp_f32 v18, v18
    v_mfma_f32_16x16x32_bf16 a[144:147], v[68:71], v[32:35], a[144:147]
    ds_read_b64_tr_b16 v[64:65], v96 offset:49408
    v_add_f32 v80, v80, v16
    v_mfma_f32_16x16x32_bf16 a[148:151], v[68:71], v[36:39], a[148:151]
    ds_read_b64_tr_b16 v[66:67], v96 offset:57600
    v_fma_f32 v19, v19, s28, -v84
    v_mfma_f32_16x16x32_bf16 a[152:155], v[68:71], v[40:43], a[152:155]
    v_add_f32 v80, v80, v18
    v_mfma_f32_16x16x32_bf16 a[156:159], v[68:71], v[44:47], a[156:159]
    s_waitcnt lgkmcnt(4)
    v_exp_f32 v19, v19
    v_mfma_f32_16x16x32_bf16 a[160:163], v[72:75], v[32:35], a[160:163]
    ds_read_b64_tr_b16 v[68:69], v97 offset:49408
    v_add_f32 v80, v80, v17
    v_mfma_f32_16x16x32_bf16 a[164:167], v[72:75], v[36:39], a[164:167]
    ds_read_b64_tr_b16 v[70:71], v97 offset:57600
    v_fma_f32 v20, v20, s28, -v85
    v_mfma_f32_16x16x32_bf16 a[168:171], v[72:75], v[40:43], a[168:171]
    buffer_load_dwordx4 v103, s[12:15], s32 offen offset:3072 lds
    v_mfma_f32_16x16x32_bf16 a[172:175], v[72:75], v[44:47], a[172:175]
    s_waitcnt lgkmcnt(4)
    v_exp_f32 v20, v20
    v_mfma_f32_16x16x32_bf16 a[176:179], v[76:79], v[32:35], a[176:179]
    s_add_u32 s32, s32, 16384
    ds_read_b64_tr_b16 v[72:73], v98 offset:49408
    v_add_f32 v80, v80, v19
    v_mfma_f32_16x16x32_bf16 a[180:183], v[76:79], v[36:39], a[180:183]
    s_cmp_eq_u32 s32, 262144
    ds_read_b64_tr_b16 v[74:75], v98 offset:57600
    v_fma_f32 v21, v21, s28, -v85
    v_mfma_f32_16x16x32_bf16 a[184:187], v[76:79], v[40:43], a[184:187]
    s_cselect_b32 s52, 16515072, 0
    v_exp_f32 v21, v21
    v_mfma_f32_16x16x32_bf16 a[188:191], v[76:79], v[44:47], a[188:191]
    s_waitcnt lgkmcnt(4)
    v_add_f32 v81, v81, v20
    v_add_f32 v81, v81, v21
    v_mfma_f32_16x16x32_bf16 a[192:195], v[64:67], v[32:35], a[192:195]
    s_add_u32 s32, s32, s52
    ds_read_b64_tr_b16 v[76:77], v99 offset:49408
    v_fma_f32 v23, v23, s28, -v85
    v_mfma_f32_16x16x32_bf16 a[196:199], v[64:67], v[36:39], a[196:199]
    ds_read_b64_tr_b16 v[78:79], v99 offset:57600
    v_fma_f32 v22, v22, s28, -v85
    v_mfma_f32_16x16x32_bf16 a[200:203], v[64:67], v[40:43], a[200:203]
    v_exp_f32 v22, v22
    v_mfma_f32_16x16x32_bf16 a[204:207], v[64:67], v[44:47], a[204:207]
    s_waitcnt lgkmcnt(4)
    v_mfma_f32_16x16x32_bf16 a[208:211], v[68:71], v[32:35], a[208:211]
    v_exp_f32 v23, v23
    v_mfma_f32_16x16x32_bf16 a[212:215], v[68:71], v[36:39], a[212:215]
    v_mfma_f32_16x16x32_bf16 a[216:219], v[68:71], v[40:43], a[216:219]
    v_mfma_f32_16x16x32_bf16 a[220:223], v[68:71], v[44:47], a[220:223]
    s_waitcnt vmcnt(10) lgkmcnt(0)
    s_barrier
    v_mfma_f32_16x16x32_bf16 a[224:227], v[72:75], v[32:35], a[224:227]
    ds_read_b128 v[64:67], v88 offset:16384
    v_add_f32 v81, v81, v22
    v_mfma_f32_16x16x32_bf16 a[228:231], v[72:75], v[36:39], a[228:231]
    ds_read_b128 v[68:71], v89 offset:16384
    v_add_f32 v81, v81, v23
    v_mfma_f32_16x16x32_bf16 a[232:235], v[72:75], v[40:43], a[232:235]
    v_mfma_f32_16x16x32_bf16 a[236:239], v[72:75], v[44:47], a[236:239]
    s_waitcnt lgkmcnt(2)
    v_mfma_f32_16x16x32_bf16 a[240:243], v[76:79], v[32:35], a[240:243]
    v_cvt_pk_bf16_f32 v34, v16, v17
    v_cvt_pk_bf16_f32 v35, v18, v19
    v_mfma_f32_16x16x32_bf16 a[244:247], v[76:79], v[36:39], a[244:247]
    v_cvt_pk_bf16_f32 v32, v0, v1
    v_cvt_pk_bf16_f32 v33, v2, v3
    v_mfma_f32_16x16x32_bf16 a[248:251], v[76:79], v[40:43], a[248:251]
    v_cvt_pk_bf16_f32 v36, v4, v5
    v_cvt_pk_bf16_f32 v37, v6, v7
    v_mfma_f32_16x16x32_bf16 a[252:255], v[76:79], v[44:47], a[252:255]
    s_waitcnt lgkmcnt(0)
    v_mfma_f32_16x16x32_bf16 v[0:3], v[64:67], a[0:3], 0
    ds_read_b128 v[72:75], v90 offset:16384
    v_cvt_pk_bf16_f32 v38, v20, v21
    v_mfma_f32_16x16x32_bf16 v[0:3], v[68:71], a[4:7], v[0:3]
    v_cvt_pk_bf16_f32 v40, v8, v9
    v_cvt_pk_bf16_f32 v41, v10, v11
    v_mfma_f32_16x16x32_bf16 v[4:7], v[64:67], a[32:35], 0
    ds_read_b128 v[76:79], v91 offset:16384
    v_cvt_pk_bf16_f32 v39, v22, v23
    v_mfma_f32_16x16x32_bf16 v[4:7], v[68:71], a[36:39], v[4:7]
    v_cvt_pk_bf16_f32 v44, v12, v13
    v_cvt_pk_bf16_f32 v45, v14, v15
    v_mfma_f32_16x16x32_bf16 v[8:11], v[64:67], a[64:67], 0
    s_mov_b32 m0, s37
    v_mfma_f32_16x16x32_bf16 v[8:11], v[68:71], a[68:71], v[8:11]
    v_fma_f32 v24, v24, s28, -v86
    v_mfma_f32_16x16x32_bf16 v[12:15], v[64:67], a[96:99], 0
    buffer_load_dwordx4 v104, s[16:19], s33 offen lds
    v_mfma_f32_16x16x32_bf16 v[12:15], v[68:71], a[100:103], v[12:15]
    s_waitcnt lgkmcnt(0)
    v_exp_f32 v24, v24
    v_mfma_f32_16x16x32_bf16 v[0:3], v[72:75], a[8:11], v[0:3]
    ds_read_b128 v[64:67], v88 offset:16640
    v_fma_f32 v25, v25, s28, -v86
    v_mfma_f32_16x16x32_bf16 v[0:3], v[76:79], a[12:15], v[0:3]
    v_exp_f32 v25, v25
    v_mfma_f32_16x16x32_bf16 v[4:7], v[72:75], a[40:43], v[4:7]
    ds_read_b128 v[68:71], v89 offset:16640
    v_cvt_pk_bf16_f32 v42, v24, v25
    v_mfma_f32_16x16x32_bf16 v[4:7], v[76:79], a[44:47], v[4:7]
    v_fma_f32 v26, v26, s28, -v86
    v_fma_f32 v27, v27, s28, -v86
    v_mfma_f32_16x16x32_bf16 v[8:11], v[72:75], a[72:75], v[8:11]
    v_exp_f32 v26, v26
    v_mfma_f32_16x16x32_bf16 v[8:11], v[76:79], a[76:79], v[8:11]
    v_add_f32 v82, v82, v24
    v_add_f32 v82, v82, v25
    v_mfma_f32_16x16x32_bf16 v[12:15], v[72:75], a[104:107], v[12:15]
    buffer_load_dwordx4 v105, s[16:19], s33 offen offset:1024 lds
    v_mfma_f32_16x16x32_bf16 v[12:15], v[76:79], a[108:111], v[12:15]
    s_waitcnt lgkmcnt(0)
    v_exp_f32 v27, v27
    v_mfma_f32_16x16x32_bf16 v[0:3], v[64:67], a[16:19], v[0:3]
    ds_read_b128 v[72:75], v90 offset:16640
    v_cvt_pk_bf16_f32 v43, v26, v27
    v_mfma_f32_16x16x32_bf16 v[0:3], v[68:71], a[20:23], v[0:3]
    v_add_f32 v82, v82, v26
    v_add_f32 v82, v82, v27
    v_mfma_f32_16x16x32_bf16 v[4:7], v[64:67], a[48:51], v[4:7]
    ds_read_b128 v[76:79], v91 offset:16640
    v_fma_f32 v28, v28, s28, -v87
    v_mfma_f32_16x16x32_bf16 v[4:7], v[68:71], a[52:55], v[4:7]
    v_exp_f32 v28, v28
    v_mfma_f32_16x16x32_bf16 v[8:11], v[64:67], a[80:83], v[8:11]
    v_fma_f32 v29, v29, s28, -v87
    v_add_f32 v83, v83, v28
    v_mfma_f32_16x16x32_bf16 v[8:11], v[68:71], a[84:87], v[8:11]
    v_exp_f32 v29, v29
    v_mfma_f32_16x16x32_bf16 v[12:15], v[64:67], a[112:115], v[12:15]
    buffer_load_dwordx4 v106, s[16:19], s33 offen offset:2048 lds
    v_mfma_f32_16x16x32_bf16 v[12:15], v[68:71], a[116:119], v[12:15]
    s_waitcnt lgkmcnt(0)
    v_add_f32 v83, v83, v29
    v_cvt_pk_bf16_f32 v46, v28, v29
    v_mfma_f32_16x16x32_bf16 v[0:3], v[72:75], a[24:27], v[0:3]
    ds_read_b128 v[64:67], v88 offset:24576
    v_fma_f32 v30, v30, s28, -v87
    v_mfma_f32_16x16x32_bf16 v[0:3], v[76:79], a[28:31], v[0:3]
    v_exp_f32 v30, v30
    v_mfma_f32_16x16x32_bf16 v[4:7], v[72:75], a[56:59], v[4:7]
    ds_read_b128 v[68:71], v89 offset:24576
    v_fma_f32 v31, v31, s28, -v87
    v_mfma_f32_16x16x32_bf16 v[4:7], v[76:79], a[60:63], v[4:7]
    v_exp_f32 v31, v31
    v_mfma_f32_16x16x32_bf16 v[8:11], v[72:75], a[88:91], v[8:11]
    v_add_f32 v83, v83, v30
    v_cvt_pk_bf16_f32 v47, v30, v31
    v_mfma_f32_16x16x32_bf16 v[8:11], v[76:79], a[92:95], v[8:11]
    v_mfma_f32_16x16x32_bf16 v[12:15], v[72:75], a[120:123], v[12:15]
    buffer_load_dwordx4 v107, s[16:19], s33 offen offset:3072 lds
    v_mfma_f32_16x16x32_bf16 v[12:15], v[76:79], a[124:127], v[12:15]
    s_waitcnt lgkmcnt(0)
    v_mfma_f32_16x16x32_bf16 v[16:19], v[64:67], a[0:3], 0
    s_add_u32 s33, s33, 16384
    ds_read_b128 v[72:75], v90 offset:24576
    v_add_f32 v83, v83, v31
    v_mfma_f32_16x16x32_bf16 v[16:19], v[68:71], a[4:7], v[16:19]
    s_mov_b32 m0, s42
    v_mfma_f32_16x16x32_bf16 v[20:23], v[64:67], a[32:35], 0
    ds_read_b128 v[76:79], v91 offset:24576
    v_fma_f32 v0, v0, s28, -v84
    v_mfma_f32_16x16x32_bf16 v[20:23], v[68:71], a[36:39], v[20:23]
    v_mfma_f32_16x16x32_bf16 v[24:27], v[64:67], a[64:67], 0
    buffer_load_dwordx4 v102, s[8:11], s41 offen offset:2048 nt lds
    v_mfma_f32_16x16x32_bf16 v[24:27], v[68:71], a[68:71], v[24:27]
    v_mfma_f32_16x16x32_bf16 v[28:31], v[64:67], a[96:99], 0
    v_exp_f32 v0, v0
    v_mfma_f32_16x16x32_bf16 v[28:31], v[68:71], a[100:103], v[28:31]
    s_waitcnt lgkmcnt(0)
    v_add_f32 v80, v80, v0
    v_mfma_f32_16x16x32_bf16 v[16:19], v[72:75], a[8:11], v[16:19]
    ds_read_b128 v[64:67], v88 offset:24832
    v_fma_f32 v1, v1, s28, -v84
    v_mfma_f32_16x16x32_bf16 v[16:19], v[76:79], a[12:15], v[16:19]
    v_exp_f32 v1, v1
    v_mfma_f32_16x16x32_bf16 v[20:23], v[72:75], a[40:43], v[20:23]
    ds_read_b128 v[68:71], v89 offset:24832
    v_fma_f32 v2, v2, s28, -v84
    v_mfma_f32_16x16x32_bf16 v[20:23], v[76:79], a[44:47], v[20:23]
    v_mfma_f32_16x16x32_bf16 v[24:27], v[72:75], a[72:75], v[24:27]
    buffer_load_dwordx4 v103, s[8:11], s41 offen offset:3072 nt lds
    v_mfma_f32_16x16x32_bf16 v[24:27], v[76:79], a[76:79], v[24:27]
    s_cmp_gt_u32 s46, 2
    v_exp_f32 v2, v2
    v_mfma_f32_16x16x32_bf16 v[28:31], v[72:75], a[104:107], v[28:31]
    s_cselect_b32 s44, 4096, 0
    v_add_f32 v80, v80, v1
    v_mfma_f32_16x16x32_bf16 v[28:31], v[76:79], a[108:111], v[28:31]
    s_waitcnt lgkmcnt(0)
    v_add_f32 v80, v80, v2
    v_mfma_f32_16x16x32_bf16 v[16:19], v[64:67], a[16:19], v[16:19]
    s_add_u32 s41, s41, s44
    ds_read_b128 v[72:75], v90 offset:24832
    v_fma_f32 v3, v3, s28, -v84
    v_mfma_f32_16x16x32_bf16 v[16:19], v[68:71], a[20:23], v[16:19]
    s_add_u32 s42, s42, s44
    v_exp_f32 v3, v3
    v_mfma_f32_16x16x32_bf16 v[20:23], v[64:67], a[48:51], v[20:23]
    ds_read_b128 v[76:79], v91 offset:24832
    v_fma_f32 v4, v4, s28, -v85
    v_mfma_f32_16x16x32_bf16 v[20:23], v[68:71], a[52:55], v[20:23]
    v_add_f32 v80, v80, v3
    v_mfma_f32_16x16x32_bf16 v[24:27], v[64:67], a[80:83], v[24:27]
    v_mfma_f32_16x16x32_bf16 v[24:27], v[68:71], a[84:87], v[24:27]
    v_exp_f32 v4, v4
    v_mfma_f32_16x16x32_bf16 v[28:31], v[64:67], a[112:115], v[28:31]
    v_mfma_f32_16x16x32_bf16 v[28:31], v[68:71], a[116:119], v[28:31]
    s_waitcnt vmcnt(12) lgkmcnt(0)
    s_barrier
    v_mfma_f32_16x16x32_bf16 v[16:19], v[72:75], a[24:27], v[16:19]
    ds_read_b64_tr_b16 v[64:65], v92 offset:32768
    v_add_f32 v81, v81, v4
    v_mfma_f32_16x16x32_bf16 v[16:19], v[76:79], a[28:31], v[16:19]
    ds_read_b64_tr_b16 v[66:67], v92 offset:40960
    v_fma_f32 v7, v7, s28, -v85
    v_mfma_f32_16x16x32_bf16 v[20:23], v[72:75], a[56:59], v[20:23]
    ds_read_b64_tr_b16 v[68:69], v93 offset:32768
    v_fma_f32 v6, v6, s28, -v85
    v_mfma_f32_16x16x32_bf16 v[20:23], v[76:79], a[60:63], v[20:23]
    ds_read_b64_tr_b16 v[70:71], v93 offset:40960
    v_fma_f32 v5, v5, s28, -v85
    v_mfma_f32_16x16x32_bf16 v[24:27], v[72:75], a[88:91], v[24:27]
    v_exp_f32 v5, v5
    v_mfma_f32_16x16x32_bf16 v[24:27], v[76:79], a[92:95], v[24:27]
    v_exp_f32 v6, v6
    v_mfma_f32_16x16x32_bf16 v[28:31], v[72:75], a[120:123], v[28:31]
    v_mfma_f32_16x16x32_bf16 v[28:31], v[76:79], a[124:127], v[28:31]
    s_waitcnt lgkmcnt(2)
    v_exp_f32 v7, v7
    v_mfma_f32_16x16x32_bf16 v[128:131], v[64:67], v[32:35], v[128:131]
    ds_read_b64_tr_b16 v[72:73], v94 offset:32768
    v_add_f32 v81, v81, v5
    v_mfma_f32_16x16x32_bf16 v[132:135], v[64:67], v[36:39], v[132:135]
    ds_read_b64_tr_b16 v[74:75], v94 offset:40960
    v_add_f32 v81, v81, v6
    v_mfma_f32_16x16x32_bf16 v[136:139], v[64:67], v[40:43], v[136:139]
    ds_read_b64_tr_b16 v[76:77], v95 offset:32768
    v_add_f32 v81, v81, v7
    v_mfma_f32_16x16x32_bf16 v[140:143], v[64:67], v[44:47], v[140:143]
    s_waitcnt lgkmcnt(3)
    ds_read_b64_tr_b16 v[78:79], v95 offset:40960
    v_mfma_f32_16x16x32_bf16 v[144:147], v[68:71], v[32:35], v[144:147]
    s_mov_b32 m0, s35
    ds_read_b64_tr_b16 v[64:65], v96 offset:32768
    v_mfma_f32_16x16x32_bf16 v[148:151], v[68:71], v[36:39], v[148:151]
    ds_read_b64_tr_b16 v[66:67], v96 offset:40960
    v_fma_f32 v8, v8, s28, -v86
    v_mfma_f32_16x16x32_bf16 v[152:155], v[68:71], v[40:43], v[152:155]
    buffer_load_dwordx4 v100, s[12:15], s32 offen lds
    v_mfma_f32_16x16x32_bf16 v[156:159], v[68:71], v[44:47], v[156:159]
    s_waitcnt lgkmcnt(4)
    v_exp_f32 v8, v8
    v_mfma_f32_16x16x32_bf16 v[160:163], v[72:75], v[32:35], v[160:163]
    s_cmp_eq_u32 s46, 2
    ds_read_b64_tr_b16 v[68:69], v97 offset:32768
    v_fma_f32 v10, v10, s28, -v86
    v_mfma_f32_16x16x32_bf16 v[164:167], v[72:75], v[36:39], v[164:167]
    s_cbranch_scc1 L_pf_0
L_pfret_0:
    ds_read_b64_tr_b16 v[70:71], v97 offset:40960
    v_fma_f32 v9, v9, s28, -v86
    v_mfma_f32_16x16x32_bf16 v[168:171], v[72:75], v[40:43], v[168:171]
    v_exp_f32 v9, v9
    v_mfma_f32_16x16x32_bf16 v[172:175], v[72:75], v[44:47], v[172:175]
    s_waitcnt lgkmcnt(4)
    v_exp_f32 v10, v10
    v_mfma_f32_16x16x32_bf16 v[176:179], v[76:79], v[32:35], v[176:179]
    ds_read_b64_tr_b16 v[72:73], v98 offset:32768
    v_fma_f32 v12, v12, s28, -v87
    v_mfma_f32_16x16x32_bf16 v[180:183], v[76:79], v[36:39], v[180:183]
    ds_read_b64_tr_b16 v[74:75], v98 offset:40960
    v_fma_f32 v11, v11, s28, -v86
    v_mfma_f32_16x16x32_bf16 v[184:187], v[76:79], v[40:43], v[184:187]
    v_exp_f32 v11, v11
    v_mfma_f32_16x16x32_bf16 v[188:191], v[76:79], v[44:47], v[188:191]
    s_waitcnt lgkmcnt(4)
    v_exp_f32 v12, v12
    v_mfma_f32_16x16x32_bf16 v[192:195], v[64:67], v[32:35], v[192:195]
    ds_read_b64_tr_b16 v[76:77], v99 offset:32768
    v_add_f32 v82, v82, v8
    v_mfma_f32_16x16x32_bf16 v[196:199], v[64:67], v[36:39], v[196:199]
    ds_read_b64_tr_b16 v[78:79], v99 offset:40960
    v_fma_f32 v13, v13, s28, -v87
    v_mfma_f32_16x16x32_bf16 v[200:203], v[64:67], v[40:43], v[200:203]
    buffer_load_dwordx4 v101, s[12:15], s32 offen offset:1024 lds
    v_mfma_f32_16x16x32_bf16 v[204:207], v[64:67], v[44:47], v[204:207]
    s_waitcnt lgkmcnt(4)
    v_exp_f32 v13, v13
    v_mfma_f32_16x16x32_bf16 v[208:211], v[68:71], v[32:35], v[208:211]
    ds_read_b64_tr_b16 v[64:65], v92 offset:33024
    v_add_f32 v82, v82, v9
    v_mfma_f32_16x16x32_bf16 v[212:215], v[68:71], v[36:39], v[212:215]
    ds_read_b64_tr_b16 v[66:67], v92 offset:41216
    v_fma_f32 v14, v14, s28, -v87
    v_mfma_f32_16x16x32_bf16 v[216:219], v[68:71], v[40:43], v[216:219]
    v_exp_f32 v14, v14
    v_mfma_f32_16x16x32_bf16 v[220:223], v[68:71], v[44:47], v[220:223]
    s_waitcnt lgkmcnt(4)
    v_add_f32 v82, v82, v10
    v_add_f32 v82, v82, v11
    v_mfma_f32_16x16x32_bf16 v[224:227], v[72:75], v[32:35], v[224:227]
    ds_read_b64_tr_b16 v[68:69], v93 offset:33024
    v_add_f32 v83, v83, v12
    v_mfma_f32_16x16x32_bf16 v[228:231], v[72:75], v[36:39], v[228:231]
    ds_read_b64_tr_b16 v[70:71], v93 offset:41216
    v_fma_f32 v15, v15, s28, -v87
    v_mfma_f32_16x16x32_bf16 v[232:235], v[72:75], v[40:43], v[232:235]
    v_exp_f32 v15, v15
    v_mfma_f32_16x16x32_bf16 v[236:239], v[72:75], v[44:47], v[236:239]
    s_waitcnt lgkmcnt(4)
    v_add_f32 v83, v83, v13
    v_add_f32 v83, v83, v14
    v_mfma_f32_16x16x32_bf16 v[240:243], v[76:79], v[32:35], v[240:243]
    ds_read_b64_tr_b16 v[72:73], v94 offset:33024
    v_add_f32 v83, v83, v15
    v_mfma_f32_16x16x32_bf16 v[244:247], v[76:79], v[36:39], v[244:247]
    ds_read_b64_tr_b16 v[74:75], v94 offset:41216
    v_fma_f32 v16, v16, s28, -v84
    v_mfma_f32_16x16x32_bf16 v[248:251], v[76:79], v[40:43], v[248:251]
    buffer_load_dwordx4 v102, s[12:15], s32 offen offset:2048 lds
    v_mfma_f32_16x16x32_bf16 v[252:255], v[76:79], v[44:47], v[252:255]
    s_waitcnt lgkmcnt(4)
    v_exp_f32 v16, v16
    v_mfma_f32_16x16x32_bf16 a[128:131], v[64:67], v[32:35], a[128:131]
    ds_read_b64_tr_b16 v[76:77], v95 offset:33024
    v_fma_f32 v18, v18, s28, -v84
    v_mfma_f32_16x16x32_bf16 a[132:135], v[64:67], v[36:39], a[132:135]
    ds_read_b64_tr_b16 v[78:79], v95 offset:41216
    v_fma_f32 v17, v17, s28, -v84
    v_mfma_f32_16x16x32_bf16 a[136:139], v[64:67], v[40:43], a[136:139]
    v_exp_f32 v17, v17
    v_mfma_f32_16x16x32_bf16 a[140:143], v[64:67], v[44:47], a[140:143]
    s_waitcnt lgkmcnt(4)
    v_exp_f32 v18, v18
    v_mfma_f32_16x16x32_bf16 a[144:147], v[68:71], v[32:35], a[144:147]
    ds_read_b64_tr_b16 v[64:65], v96 offset:33024
    v_add_f32 v80, v80, v16
    v_mfma_f32_16x16x32_bf16 a[148:151], v[68:71], v[36:39], a[148:151]
    ds_read_b64_tr_b16 v[66:67], v96 offset:41216
    v_fma_f32 v19, v19, s28, -v84
    v_mfma_f32_16x16x32_bf16 a[152:155], v[68:71], v[40:43], a[152:155]
    v_add_f32 v80, v80, v18
    v_mfma_f32_16x16x32_bf16 a[156:159], v[68:71], v[44:47], a[156:159]
    s_waitcnt lgkmcnt(4)
    v_exp_f32 v19, v19
    v_mfma_f32_16x16x32_bf16 a[160:163], v[72:75], v[32:35], a[160:163]
    ds_read_b64_tr_b16 v[68:69], v97 offset:33024
    v_add_f32 v80, v80, v17
    v_mfma_f32_16x16x32_bf16 a[164:167], v[72:75], v[36:39], a[164:167]
    ds_read_b64_tr_b16 v[70:71], v97 offset:41216
    v_fma_f32 v20, v20, s28, -v85
    v_mfma_f32_16x16x32_bf16 a[168:171], v[72:75], v[40:43], a[168:171]
    buffer_load_dwordx4 v103, s[12:15], s32 offen offset:3072 lds
    v_mfma_f32_16x16x32_bf16 a[172:175], v[72:75], v[44:47], a[172:175]
    s_waitcnt lgkmcnt(4)
    v_exp_f32 v20, v20
    v_mfma_f32_16x16x32_bf16 a[176:179], v[76:79], v[32:35], a[176:179]
    s_add_u32 s32, s32, 16384
    ds_read_b64_tr_b16 v[72:73], v98 offset:33024
    v_add_f32 v80, v80, v19
    v_mfma_f32_16x16x32_bf16 a[180:183], v[76:79], v[36:39], a[180:183]
    s_cmp_eq_u32 s32, 262144
    ds_read_b64_tr_b16 v[74:75], v98 offset:41216
    v_fma_f32 v21, v21, s28, -v85
    v_mfma_f32_16x16x32_bf16 a[184:187], v[76:79], v[40:43], a[184:187]
    s_cselect_b32 s52, 16515072, 0
    v_exp_f32 v21, v21
    v_mfma_f32_16x16x32_bf16 a[188:191], v[76:79], v[44:47], a[188:191]
    s_waitcnt lgkmcnt(4)
    v_add_f32 v81, v81, v20
    v_add_f32 v81, v81, v21
    v_mfma_f32_16x16x32_bf16 a[192:195], v[64:67], v[32:35], a[192:195]
    s_add_u32 s32, s32, s52
    ds_read_b64_tr_b16 v[76:77], v99 offset:33024
    v_fma_f32 v23, v23, s28, -v85
    v_mfma_f32_16x16x32_bf16 a[196:199], v[64:67], v[36:39], a[196:199]
    ds_read_b64_tr_b16 v[78:79], v99 offset:41216
    v_fma_f32 v22, v22, s28, -v85
    v_mfma_f32_16x16x32_bf16 a[200:203], v[64:67], v[40:43], a[200:203]
    v_exp_f32 v22, v22
    v_mfma_f32_16x16x32_bf16 a[204:207], v[64:67], v[44:47], a[204:207]
    s_waitcnt lgkmcnt(4)
    v_mfma_f32_16x16x32_bf16 a[208:211], v[68:71], v[32:35], a[208:211]
    v_exp_f32 v23, v23
    v_mfma_f32_16x16x32_bf16 a[212:215], v[68:71], v[36:39], a[212:215]
    v_mfma_f32_16x16x32_bf16 a[216:219], v[68:71], v[40:43], a[216:219]
    v_mfma_f32_16x16x32_bf16 a[220:223], v[68:71], v[44:47], a[220:223]
    s_waitcnt vmcnt(10) lgkmcnt(0)
    s_barrier
    v_mfma_f32_16x16x32_bf16 a[224:227], v[72:75], v[32:35], a[224:227]
    ds_read_b128 v[64:67], v88 offset:0
    v_add_f32 v81, v81, v22
    v_mfma_f32_16x16x32_bf16 a[228:231], v[72:75], v[36:39], a[228:231]
    s_sub_u32 s46, s46, 1
    ds_read_b128 v[68:71], v89 offset:0
    v_add_f32 v81, v81, v23
    v_mfma_f32_16x16x32_bf16 a[232:235], v[72:75], v[40:43], a[232:235]
    s_cmp_lg_u32 s46, 0
    v_mfma_f32_16x16x32_bf16 a[236:239], v[72:75], v[44:47], a[236:239]
    s_waitcnt lgkmcnt(2)
    v_mfma_f32_16x16x32_bf16 a[240:243], v[76:79], v[32:35], a[240:243]
    v_cvt_pk_bf16_f32 v34, v16, v17
    v_cvt_pk_bf16_f32 v35, v18, v19
    v_mfma_f32_16x16x32_bf16 a[244:247], v[76:79], v[36:39], a[244:247]
    v_cvt_pk_bf16_f32 v32, v0, v1
    v_cvt_pk_bf16_f32 v33, v2, v3
    v_mfma_f32_16x16x32_bf16 a[248:251], v[76:79], v[40:43], a[248:251]
    v_cvt_pk_bf16_f32 v36, v4, v5
    v_cvt_pk_bf16_f32 v37, v6, v7
    v_mfma_f32_16x16x32_bf16 a[252:255], v[76:79], v[44:47], a[252:255]
    s_waitcnt lgkmcnt(0)
    s_cbranch_scc1 L_loop0
L_loop0_end:
L_fe0:
    s_waitcnt vmcnt(4) lgkmcnt(0)
    s_barrier
    ds_read_b64_tr_b16 v[64:65], v92 offset:49152
    ds_read_b64_tr_b16 v[66:67], v92 offset:57344
    ds_read_b64_tr_b16 v[68:69], v93 offset:49152
    ds_read_b64_tr_b16 v[70:71], v93 offset:57344
    ds_read_b64_tr_b16 v[72:73], v94 offset:49152
    ds_read_b64_tr_b16 v[74:75], v94 offset:57344
    s_add_u32 s33, s33, 16515072
    s_mov_b32 m0, s36
    s_nop 0
    buffer_load_dwordx4 v104, s[16:19], s33 offen lds
    buffer_load_dwordx4 v105, s[16:19], s33 offen offset:1024 lds
    buffer_load_dwordx4 v106, s[16:19], s33 offen offset:2048 lds
    buffer_load_dwordx4 v107, s[16:19], s33 offen offset:3072 lds
    s_add_u32 s33, s33, 16384
    v_lshrrev_b32 v120, 3, v118
    s_and_b32 s50, s30, 1
    v_xor_b32 v120, s50, v120
    v_and_b32 v120, 1, v120
    v_lshlrev_b32 v120, 7, v120
    v_xor_b32 v110, v120, v88
    v_add_u32 v110, s45, v110
    v_xor_b32 v111, v120, v89
    v_add_u32 v111, s45, v111
    v_xor_b32 v112, v120, v90
    v_add_u32 v112, s45, v112
    v_xor_b32 v113, v120, v91
    v_add_u32 v113, s45, v113
    v_cvt_pk_bf16_f32 v38, v20, v21
    v_cvt_pk_bf16_f32 v40, v8, v9
    v_cvt_pk_bf16_f32 v41, v10, v11
    v_cvt_pk_bf16_f32 v39, v22, v23
    v_cvt_pk_bf16_f32 v44, v12, v13
    v_cvt_pk_bf16_f32 v45, v14, v15
    v_fma_f32 v24, v24, s28, -v86
    v_exp_f32 v24, v24
    v_fma_f32 v25, v25, s28, -v86
    v_exp_f32 v25, v25
    s_nop 0
    v_cvt_pk_bf16_f32 v42, v24, v25
    v_fma_f32 v26, v26, s28, -v86
    v_fma_f32 v27, v27, s28, -v86
    v_exp_f32 v26, v26
    v_add_f32 v82, v82, v24
    v_add_f32 v82, v82, v25
    v_exp_f32 v27, v27
    s_nop 0
    v_cvt_pk_bf16_f32 v43, v26, v27
    v_add_f32 v82, v82, v26
    v_add_f32 v82, v82, v27
    v_fma_f32 v28, v28, s28, -v87
    v_exp_f32 v28, v28
    v_fma_f32 v29, v29, s28, -v87
    v_add_f32 v83, v83, v28
    v_exp_f32 v29, v29
    s_nop 0
    v_add_f32 v83, v83, v29
    v_cvt_pk_bf16_f32 v46, v28, v29
    v_fma_f32 v30, v30, s28, -v87
    v_exp_f32 v30, v30
    v_fma_f32 v31, v31, s28, -v87
    v_exp_f32 v31, v31
    v_add_f32 v83, v83, v30
    v_cvt_pk_bf16_f32 v47, v30, v31
    v_add_f32 v83, v83, v31
    s_nop 1
    s_waitcnt lgkmcnt(4)
    v_mfma_f32_16x16x32_bf16 v[128:131], v[64:67], v[32:35], v[128:131]
    ds_read_b64_tr_b16 v[76:77], v95 offset:49152
    v_mov_b32 v120, v80
    v_mov_b32 v121, v81
    v_mov_b32 v122, v82
    v_mfma_f32_16x16x32_bf16 v[132:135], v[64:67], v[36:39], v[132:135]
    ds_read_b64_tr_b16 v[78:79], v95 offset:57344
    v_mov_b32 v123, v83
    s_nop 1
    v_permlane16_swap_b32 v80, v120
    v_mfma_f32_16x16x32_bf16 v[136:139], v[64:67], v[40:43], v[136:139]
    buffer_load_dwordx4 a[96:99], v108, s[8:11], s39 offen nt
    v_permlane16_swap_b32 v81, v121
    v_permlane16_swap_b32 v82, v122
    v_permlane16_swap_b32 v83, v123
    v_mfma_f32_16x16x32_bf16 v[140:143], v[64:67], v[44:47], v[140:143]
    s_waitcnt lgkmcnt(4)
    buffer_load_dwordx4 a[100:103], v108, s[8:11], s39 offen offset:64 nt
    s_nop 1
    v_add_f32 v80, v80, v120
    v_add_f32 v81, v81, v121
    v_mfma_f32_16x16x32_bf16 v[144:147], v[68:71], v[32:35], v[144:147]
    ds_read_b64_tr_b16 v[64:65], v96 offset:49152
    v_add_f32 v82, v82, v122
    v_add_f32 v83, v83, v123
    v_mov_b32 v120, v80
    v_mfma_f32_16x16x32_bf16 v[148:151], v[68:71], v[36:39], v[148:151]
    ds_read_b64_tr_b16 v[66:67], v96 offset:57344
    v_mov_b32 v121, v81
    v_mov_b32 v122, v82
    v_mov_b32 v123, v83
    v_mfma_f32_16x16x32_bf16 v[152:155], v[68:71], v[40:43], v[152:155]
    buffer_load_dwordx4 a[104:107], v108, s[8:11], s39 offen offset:128 nt
    s_nop 1
    v_permlane32_swap_b32 v80, v120
    v_permlane32_swap_b32 v81, v121
    v_mfma_f32_16x16x32_bf16 v[156:159], v[68:71], v[44:47], v[156:159]
    s_waitcnt lgkmcnt(4)
    buffer_load_dwordx4 a[108:111], v108, s[8:11], s39 offen offset:192 nt
    v_permlane32_swap_b32 v82, v122
    v_permlane32_swap_b32 v83, v123
    s_nop 1
    v_mfma_f32_16x16x32_bf16 v[160:163], v[72:75], v[32:35], v[160:163]
    ds_read_b64_tr_b16 v[68:69], v97 offset:49152
    v_add_f32 v80, v80, v120
    v_add_f32 v81, v81, v121
    v_add_f32 v82, v82, v122
    v_mfma_f32_16x16x32_bf16 v[164:167], v[72:75], v[36:39], v[164:167]
    ds_read_b64_tr_b16 v[70:71], v97 offset:57344
    v_add_f32 v83, v83, v123
    v_cmp_nge_f32 s[50:51], s29, v80
    v_cmp_nge_f32 s[52:53], s29, v81
    v_mfma_f32_16x16x32_bf16 v[168:171], v[72:75], v[40:43], v[168:171]
    buffer_load_dwordx4 a[112:115], v108, s[8:11], s39 offen offset:256 nt
    v_cmp_nge_f32 s[54:55], s29, v82
    v_cmp_nge_f32 s[56:57], s29, v83
    v_rcp_f32 v80, v80
    v_mfma_f32_16x16x32_bf16 v[172:175], v[72:75], v[44:47], v[172:175]
    s_waitcnt lgkmcnt(4)
    buffer_load_dwordx4 a[116:119], v108, s[8:11], s39 offen offset:320 nt
    v_rcp_f32 v81, v81
    v_rcp_f32 v82, v82
    v_rcp_f32 v83, v83
    v_mfma_f32_16x16x32_bf16 v[176:179], v[76:79], v[32:35], v[176:179]
    ds_read_b64_tr_b16 v[72:73], v98 offset:49152
    s_nop 0
    v_mov_b32 v87, v83
    v_mov_b32 v86, v83
    v_mfma_f32_16x16x32_bf16 v[180:183], v[76:79], v[36:39], v[180:183]
    ds_read_b64_tr_b16 v[74:75], v98 offset:57344
    v_mov_b32 v85, v82
    v_mov_b32 v84, v82
    v_mov_b32 v83, v81
    v_mfma_f32_16x16x32_bf16 v[184:187], v[76:79], v[40:43], v[184:187]
    buffer_load_dwordx4 a[120:123], v108, s[8:11], s39 offen offset:384 nt
    v_mov_b32 v82, v81
    v_mov_b32 v81, v80
    s_nop 0
    v_mfma_f32_16x16x32_bf16 v[188:191], v[76:79], v[44:47], v[188:191]
    s_waitcnt lgkmcnt(4)
    buffer_load_dwordx4 a[124:127], v108, s[8:11], s39 offen offset:448 nt
    s_or_b64 s[50:51], s[50:51], s[52:53]
    s_or_b64 s[54:55], s[54:55], s[56:57]
    s_or_b64 s[48:49], s[50:51], s[54:55]
    v_mfma_f32_16x16x32_bf16 v[192:195], v[64:67], v[32:35], v[192:195]
    ds_read_b64_tr_b16 v[76:77], v99 offset:49152
    v_pk_mul_f32 v[128:129], v[128:129], v[80:81]
    v_pk_mul_f32 v[130:131], v[130:131], v[80:81]
    v_pk_mul_f32 v[144:145], v[144:145], v[80:81]
    v_pk_mul_f32 v[146:147], v[146:147], v[80:81]
    v_mfma_f32_16x16x32_bf16 v[196:199], v[64:67], v[36:39], v[196:199]
    ds_read_b64_tr_b16 v[78:79], v99 offset:57344
    v_cvt_pk_bf16_f32 v128, v128, v129
    v_cvt_pk_bf16_f32 v129, v130, v131
    v_cvt_pk_bf16_f32 v130, v144, v145
    v_mfma_f32_16x16x32_bf16 v[200:203], v[64:67], v[40:43], v[200:203]
    ds_read_b128 a[0:3], v110 offset:0
    v_cvt_pk_bf16_f32 v131, v146, v147
    v_pk_mul_f32 v[160:161], v[160:161], v[80:81]
    v_pk_mul_f32 v[162:163], v[162:163], v[80:81]
    v_mfma_f32_16x16x32_bf16 v[204:207], v[64:67], v[44:47], v[204:207]
    s_waitcnt lgkmcnt(5)
    ds_read_b128 a[4:7], v111 offset:0
    v_permlane16_swap_b32 v128, v130
    v_permlane16_swap_b32 v129, v131
    v_pk_mul_f32 v[176:177], v[176:177], v[80:81]
    v_mfma_f32_16x16x32_bf16 v[208:211], v[68:71], v[32:35], v[208:211]
    ds_read_b64_tr_b16 v[64:65], v92 offset:49408
    v_pk_mul_f32 v[178:179], v[178:179], v[80:81]
    v_cvt_pk_bf16_f32 v160, v160, v161
    v_cvt_pk_bf16_f32 v161, v162, v163
    v_cvt_pk_bf16_f32 v162, v176, v177
    v_mfma_f32_16x16x32_bf16 v[212:215], v[68:71], v[36:39], v[212:215]
    ds_read_b64_tr_b16 v[66:67], v92 offset:57600
    v_cvt_pk_bf16_f32 v163, v178, v179
    v_pk_mul_f32 v[132:133], v[132:133], v[82:83]
    v_pk_mul_f32 v[134:135], v[134:135], v[82:83]
    v_mfma_f32_16x16x32_bf16 v[216:219], v[68:71], v[40:43], v[216:219]
    ds_read_b128 a[8:11], v112 offset:0
    v_permlane16_swap_b32 v160, v162
    v_permlane16_swap_b32 v161, v163
    v_pk_mul_f32 v[148:149], v[148:149], v[82:83]
    v_mfma_f32_16x16x32_bf16 v[220:223], v[68:71], v[44:47], v[220:223]
    s_waitcnt lgkmcnt(7)
    ds_read_b128 a[12:15], v113 offset:0
    v_pk_mul_f32 v[150:151], v[150:151], v[82:83]
    v_cvt_pk_bf16_f32 v132, v132, v133
    v_cvt_pk_bf16_f32 v133, v134, v135
    v_mfma_f32_16x16x32_bf16 v[224:227], v[72:75], v[32:35], v[224:227]
    ds_read_b64_tr_b16 v[68:69], v93 offset:49408
    v_cvt_pk_bf16_f32 v134, v148, v149
    v_cvt_pk_bf16_f32 v135, v150, v151
    v_pk_mul_f32 v[164:165], v[164:165], v[82:83]
    v_pk_mul_f32 v[166:167], v[166:167], v[82:83]
    v_mfma_f32_16x16x32_bf16 v[228:231], v[72:75], v[36:39], v[228:231]
    ds_read_b64_tr_b16 v[70:71], v93 offset:57600
    v_permlane16_swap_b32 v132, v134
    v_permlane16_swap_b32 v133, v135
    v_pk_mul_f32 v[180:181], v[180:181], v[82:83]
    v_mfma_f32_16x16x32_bf16 v[232:235], v[72:75], v[40:43], v[232:235]
    ds_read_b128 a[16:19], v110 offset:256
    v_pk_mul_f32 v[182:183], v[182:183], v[82:83]
    v_cvt_pk_bf16_f32 v164, v164, v165
    v_cvt_pk_bf16_f32 v165, v166, v167
    v_mfma_f32_16x16x32_bf16 v[236:239], v[72:75], v[44:47], v[236:239]
    s_waitcnt lgkmcnt(9)
    ds_read_b128 a[20:23], v111 offset:256
    v_cvt_pk_bf16_f32 v166, v180, v181
    v_cvt_pk_bf16_f32 v167, v182, v183
    v_pk_mul_f32 v[136:137], v[136:137], v[84:85]
    v_mfma_f32_16x16x32_bf16 v[240:243], v[76:79], v[32:35], v[240:243]
    ds_read_b64_tr_b16 v[72:73], v94 offset:49408
    v_pk_mul_f32 v[138:139], v[138:139], v[84:85]
    v_permlane16_swap_b32 v164, v166
    v_permlane16_swap_b32 v165, v167
    v_pk_mul_f32 v[152:153], v[152:153], v[84:85]
    v_mfma_f32_16x16x32_bf16 v[244:247], v[76:79], v[36:39], v[244:247]
    ds_read_b64_tr_b16 v[74:75], v94 offset:57600
    v_pk_mul_f32 v[154:155], v[154:155], v[84:85]
    v_cvt_pk_bf16_f32 v136, v136, v137
    v_cvt_pk_bf16_f32 v137, v138, v139
    v_mfma_f32_16x16x32_bf16 v[248:251], v[76:79], v[40:43], v[248:251]
    ds_read_b128 a[24:27], v112 offset:256
    v_cvt_pk_bf16_f32 v138, v152, v153
    v_cvt_pk_bf16_f32 v139, v154, v155
    v_pk_mul_f32 v[168:169], v[168:169], v[84:85]
    v_mfma_f32_16x16x32_bf16 v[252:255], v[76:79], v[44:47], v[252:255]
    s_waitcnt lgkmcnt(9)
    ds_read_b128 a[28:31], v113 offset:256
    v_pk_mul_f32 v[170:171], v[170:171], v[84:85]
    v_permlane16_swap_b32 v136, v138
    v_permlane16_swap_b32 v137, v139
    v_mfma_f32_16x16x32_bf16 a[128:131], v[64:67], v[32:35], a[128:131]
    ds_read_b64_tr_b16 v[76:77], v95 offset:49408
    v_pk_mul_f32 v[184:185], v[184:185], v[84:85]
    v_pk_mul_f32 v[186:187], v[186:187], v[84:85]
    v_cvt_pk_bf16_f32 v168, v168, v169
    v_cvt_pk_bf16_f32 v169, v170, v171
    v_mfma_f32_16x16x32_bf16 a[132:135], v[64:67], v[36:39], a[132:135]
    ds_read_b64_tr_b16 v[78:79], v95 offset:57600
    v_cvt_pk_bf16_f32 v170, v184, v185
    v_cvt_pk_bf16_f32 v171, v186, v187
    v_pk_mul_f32 v[140:141], v[140:141], v[86:87]
    v_mfma_f32_16x16x32_bf16 a[136:139], v[64:67], v[40:43], a[136:139]
    ds_read_b128 a[32:35], v110 offset:8192
    v_pk_mul_f32 v[142:143], v[142:143], v[86:87]
    v_permlane16_swap_b32 v168, v170
    v_permlane16_swap_b32 v169, v171
    v_mfma_f32_16x16x32_bf16 a[140:143], v[64:67], v[44:47], a[140:143]
    s_waitcnt lgkmcnt(9)
    ds_read_b128 a[36:39], v111 offset:8192
    v_pk_mul_f32 v[156:157], v[156:157], v[86:87]
    v_pk_mul_f32 v[158:159], v[158:159], v[86:87]
    v_cvt_pk_bf16_f32 v140, v140, v141
    v_mfma_f32_16x16x32_bf16 a[144:147], v[68:71], v[32:35], a[144:147]
    ds_read_b64_tr_b16 v[64:65], v96 offset:49408
    v_cvt_pk_bf16_f32 v141, v142, v143
    v_cvt_pk_bf16_f32 v142, v156, v157
    v_cvt_pk_bf16_f32 v143, v158, v159
    v_pk_mul_f32 v[172:173], v[172:173], v[86:87]
    v_mfma_f32_16x16x32_bf16 a[148:151], v[68:71], v[36:39], a[148:151]
    ds_read_b64_tr_b16 v[66:67], v96 offset:57600
    v_pk_mul_f32 v[174:175], v[174:175], v[86:87]
    v_permlane16_swap_b32 v140, v142
    v_permlane16_swap_b32 v141, v143
    v_mfma_f32_16x16x32_bf16 a[152:155], v[68:71], v[40:43], a[152:155]
    ds_read_b128 a[40:43], v112 offset:8192
    v_pk_mul_f32 v[188:189], v[188:189], v[86:87]
    v_pk_mul_f32 v[190:191], v[190:191], v[86:87]
    v_cvt_pk_bf16_f32 v172, v172, v173
    v_mfma_f32_16x16x32_bf16 a[156:159], v[68:71], v[44:47], a[156:159]
    s_waitcnt lgkmcnt(9)
    ds_read_b128 a[44:47], v113 offset:8192
    v_cvt_pk_bf16_f32 v173, v174, v175
    v_cvt_pk_bf16_f32 v174, v188, v189
    v_cvt_pk_bf16_f32 v175, v190, v191
    v_mfma_f32_16x16x32_bf16 a[160:163], v[72:75], v[32:35], a[160:163]
    ds_read_b64_tr_b16 v[68:69], v97 offset:49408
    v_pk_mul_f32 v[192:193], v[192:193], v[80:81]
    v_pk_mul_f32 v[194:195], v[194:195], v[80:81]
    v_permlane16_swap_b32 v172, v174
    v_permlane16_swap_b32 v173, v175
    v_mfma_f32_16x16x32_bf16 a[164:167], v[72:75], v[36:39], a[164:167]
    ds_read_b64_tr_b16 v[70:71], v97 offset:57600
    s_add_u32 s52, s40, 0
    buffer_store_dwordx4 v[128:131], v109, s[20:23], s52 offen
    v_pk_mul_f32 v[208:209], v[208:209], v[80:81]
    v_pk_mul_f32 v[210:211], v[210:211], v[80:81]
    v_mfma_f32_16x16x32_bf16 a[168:171], v[72:75], v[40:43], a[168:171]
    ds_read_b128 a[48:51], v110 offset:8448
    v_cvt_pk_bf16_f32 v56, v192, v193
    v_cvt_pk_bf16_f32 v57, v194, v195
    v_cvt_pk_bf16_f32 v58, v208, v209
    v_cvt_pk_bf16_f32 v59, v210, v211
    v_mfma_f32_16x16x32_bf16 a[172:175], v[72:75], v[44:47], a[172:175]
    s_waitcnt lgkmcnt(9)
    ds_read_b128 a[52:55], v111 offset:8448
    v_pk_mul_f32 v[224:225], v[224:225], v[80:81]
    v_pk_mul_f32 v[226:227], v[226:227], v[80:81]
    v_permlane16_swap_b32 v56, v58
    v_permlane16_swap_b32 v57, v59
    v_mfma_f32_16x16x32_bf16 a[176:179], v[76:79], v[32:35], a[176:179]
    ds_read_b64_tr_b16 v[72:73], v98 offset:49408
    v_pk_mul_f32 v[240:241], v[240:241], v[80:81]
    v_pk_mul_f32 v[242:243], v[242:243], v[80:81]
    ds_write_b128 v115, v[56:59] offset:0
    v_cvt_pk_bf16_f32 v60, v224, v225
    v_mfma_f32_16x16x32_bf16 a[180:183], v[76:79], v[36:39], a[180:183]
    ds_read_b64_tr_b16 v[74:75], v98 offset:57600
    v_cvt_pk_bf16_f32 v61, v226, v227
    v_cvt_pk_bf16_f32 v62, v240, v241
    v_cvt_pk_bf16_f32 v63, v242, v243
    v_pk_mul_f32 v[196:197], v[196:197], v[82:83]
    v_mfma_f32_16x16x32_bf16 a[184:187], v[76:79], v[40:43], a[184:187]
    ds_read_b128 a[56:59], v112 offset:8448
    v_pk_mul_f32 v[198:199], v[198:199], v[82:83]
    v_permlane16_swap_b32 v60, v62
    v_permlane16_swap_b32 v61, v63
    v_pk_mul_f32 v[212:213], v[212:213], v[82:83]
    v_mfma_f32_16x16x32_bf16 a[188:191], v[76:79], v[44:47], a[188:191]
    s_waitcnt lgkmcnt(10)
    ds_read_b128 a[60:63], v113 offset:8448
    v_pk_mul_f32 v[214:215], v[214:215], v[82:83]
    ds_write_b128 v116, v[60:63] offset:0
    v_cvt_pk_bf16_f32 v56, v196, v197
    v_mfma_f32_16x16x32_bf16 a[192:195], v[64:67], v[32:35], a[192:195]
    ds_read_b64_tr_b16 v[76:77], v99 offset:49408
    v_cvt_pk_bf16_f32 v57, v198, v199
    v_cvt_pk_bf16_f32 v58, v212, v213
    v_cvt_pk_bf16_f32 v59, v214, v215
    s_add_u32 s52, s40, 0
    v_mfma_f32_16x16x32_bf16 a[196:199], v[64:67], v[36:39], a[196:199]
    ds_read_b64_tr_b16 v[78:79], v99 offset:57600
    buffer_store_dwordx4 v[160:163], v109, s[20:23], s52 offen offset:64
    v_pk_mul_f32 v[228:229], v[228:229], v[82:83]
    v_pk_mul_f32 v[230:231], v[230:231], v[82:83]
    v_permlane16_swap_b32 v56, v58
    v_mfma_f32_16x16x32_bf16 a[200:203], v[64:67], v[40:43], a[200:203]
    ds_read_b128 a[64:67], v110 offset:16384
    v_permlane16_swap_b32 v57, v59
    v_pk_mul_f32 v[244:245], v[244:245], v[82:83]
    v_pk_mul_f32 v[246:247], v[246:247], v[82:83]
    ds_write_b128 v115, v[56:59] offset:2048
    v_mfma_f32_16x16x32_bf16 a[204:207], v[64:67], v[44:47], a[204:207]
    s_waitcnt lgkmcnt(12)
    ds_read_b128 a[68:71], v111 offset:16384
    v_cvt_pk_bf16_f32 v60, v228, v229
    v_cvt_pk_bf16_f32 v61, v230, v231
    v_cvt_pk_bf16_f32 v62, v244, v245
    v_cvt_pk_bf16_f32 v63, v246, v247
    v_mfma_f32_16x16x32_bf16 a[208:211], v[68:71], v[32:35], a[208:211]
    v_pk_mul_f32 v[200:201], v[200:201], v[84:85]
    v_pk_mul_f32 v[202:203], v[202:203], v[84:85]
    v_permlane16_swap_b32 v60, v62
    v_permlane16_swap_b32 v61, v63
    v_mfma_f32_16x16x32_bf16 a[212:215], v[68:71], v[36:39], a[212:215]
    v_pk_mul_f32 v[216:217], v[216:217], v[84:85]
    v_pk_mul_f32 v[218:219], v[218:219], v[84:85]
    ds_write_b128 v116, v[60:63] offset:2048
    v_cvt_pk_bf16_f32 v56, v200, v201
    v_mfma_f32_16x16x32_bf16 a[216:219], v[68:71], v[40:43], a[216:219]
    ds_read_b128 a[72:75], v112 offset:16384
    v_cvt_pk_bf16_f32 v57, v202, v203
    v_cvt_pk_bf16_f32 v58, v216, v217
    v_cvt_pk_bf16_f32 v59, v218, v219
    v_pk_mul_f32 v[232:233], v[232:233], v[84:85]
    v_mfma_f32_16x16x32_bf16 a[220:223], v[68:71], v[44:47], a[220:223]
    s_waitcnt lgkmcnt(10)
    ds_read_b128 a[76:79], v113 offset:16384
    v_pk_mul_f32 v[234:235], v[234:235], v[84:85]
    v_permlane16_swap_b32 v56, v58
    v_permlane16_swap_b32 v57, v59
    v_mfma_f32_16x16x32_bf16 a[224:227], v[72:75], v[32:35], a[224:227]
    v_pk_mul_f32 v[248:249], v[248:249], v[84:85]
    v_pk_mul_f32 v[250:251], v[250:251], v[84:85]
    s_add_u32 s52, s40, 8192
    buffer_store_dwordx4 v[132:135], v109, s[20:23], s52 offen
    v_mfma_f32_16x16x32_bf16 a[228:231], v[72:75], v[36:39], a[228:231]
    ds_write_b128 v115, v[56:59] offset:4096
    v_cvt_pk_bf16_f32 v60, v232, v233
    v_cvt_pk_bf16_f32 v61, v234, v235
    v_cvt_pk_bf16_f32 v62, v248, v249
    v_mfma_f32_16x16x32_bf16 a[232:235], v[72:75], v[40:43], a[232:235]
    ds_read_b128 a[80:83], v110 offset:16640
    v_cvt_pk_bf16_f32 v63, v250, v251
    v_pk_mul_f32 v[204:205], v[204:205], v[86:87]
    v_pk_mul_f32 v[206:207], v[206:207], v[86:87]
    v_permlane16_swap_b32 v60, v62
    v_mfma_f32_16x16x32_bf16 a[236:239], v[72:75], v[44:47], a[236:239]
    s_waitcnt lgkmcnt(8)
    ds_read_b128 a[84:87], v111 offset:16640
    v_permlane16_swap_b32 v61, v63
    v_pk_mul_f32 v[220:221], v[220:221], v[86:87]
    v_pk_mul_f32 v[222:223], v[222:223], v[86:87]
    ds_write_b128 v116, v[60:63] offset:4096
    v_mfma_f32_16x16x32_bf16 a[240:243], v[76:79], v[32:35], a[240:243]
    v_cvt_pk_bf16_f32 v56, v204, v205
    v_cvt_pk_bf16_f32 v57, v206, v207
    v_cvt_pk_bf16_f32 v58, v220, v221
    v_cvt_pk_bf16_f32 v59, v222, v223
    v_mfma_f32_16x16x32_bf16 a[244:247], v[76:79], v[36:39], a[244:247]
    v_pk_mul_f32 v[236:237], v[236:237], v[86:87]
    v_pk_mul_f32 v[238:239], v[238:239], v[86:87]
    v_permlane16_swap_b32 v56, v58
    v_permlane16_swap_b32 v57, v59
    v_mfma_f32_16x16x32_bf16 a[248:251], v[76:79], v[40:43], a[248:251]
    ds_read_b128 a[88:91], v112 offset:16640
    v_pk_mul_f32 v[252:253], v[252:253], v[86:87]
    v_pk_mul_f32 v[254:255], v[254:255], v[86:87]
    ds_write_b128 v115, v[56:59] offset:6144
    v_cvt_pk_bf16_f32 v60, v236, v237
    v_mfma_f32_16x16x32_bf16 a[252:255], v[76:79], v[44:47], a[252:255]
    ds_read_b128 a[92:95], v113 offset:16640
    v_cvt_pk_bf16_f32 v61, v238, v239
    v_cvt_pk_bf16_f32 v62, v252, v253
    v_cvt_pk_bf16_f32 v63, v254, v255
    ds_read_b128 v[64:67], v88 offset:0
    ds_read_b128 v[68:71], v89 offset:0
    ds_read_b128 v[72:75], v90 offset:0
    s_waitcnt vmcnt(10) lgkmcnt(2)
    v_mfma_f32_16x16x32_bf16 v[0:3], v[64:67], a[0:3], 0
    ds_read_b128 v[76:79], v91 offset:0
    v_accvgpr_read_b32 v120, a128
    v_accvgpr_read_b32 v121, a129
    v_permlane16_swap_b32 v60, v62
    v_permlane16_swap_b32 v61, v63
    s_add_u32 s52, s40, 8192
    v_mfma_f32_16x16x32_bf16 v[4:7], v[64:67], a[32:35], 0
    buffer_store_dwordx4 v[164:167], v109, s[20:23], s52 offen offset:64
    v_accvgpr_read_b32 v122, a130
    v_accvgpr_read_b32 v123, a131
    ds_write_b128 v116, v[60:63] offset:6144
    v_accvgpr_read_b32 v124, a144
    v_mfma_f32_16x16x32_bf16 v[8:11], v[64:67], a[64:67], 0
    v_accvgpr_read_b32 v125, a145
    v_accvgpr_read_b32 v126, a146
    v_accvgpr_read_b32 v127, a147
    v_pk_mul_f32 v[120:121], v[120:121], v[80:81]
    v_pk_mul_f32 v[122:123], v[122:123], v[80:81]
    v_mfma_f32_16x16x32_bf16 v[12:15], v[64:67], a[96:99], 0
    s_waitcnt vmcnt(10) lgkmcnt(3)
    v_pk_mul_f32 v[124:125], v[124:125], v[80:81]
    v_pk_mul_f32 v[126:127], v[126:127], v[80:81]
    v_cvt_pk_bf16_f32 v56, v120, v121
    v_cvt_pk_bf16_f32 v57, v122, v123
    v_cvt_pk_bf16_f32 v58, v124, v125
    v_mfma_f32_16x16x32_bf16 v[0:3], v[68:71], a[4:7], v[0:3]
    ds_read_b128 v[64:67], v88 offset:256
    v_cvt_pk_bf16_f32 v59, v126, v127
    v_accvgpr_read_b32 v48, a160
    v_accvgpr_read_b32 v49, a161
    v_permlane16_swap_b32 v56, v58
    v_permlane16_swap_b32 v57, v59
    v_mfma_f32_16x16x32_bf16 v[4:7], v[68:71], a[36:39], v[4:7]
    v_accvgpr_read_b32 v50, a162
    v_accvgpr_read_b32 v51, a163
    ds_write_b128 v115, v[56:59] offset:8192
    v_accvgpr_read_b32 v52, a176
    v_accvgpr_read_b32 v53, a177
    v_mfma_f32_16x16x32_bf16 v[8:11], v[68:71], a[68:71], v[8:11]
    v_accvgpr_read_b32 v54, a178
    v_accvgpr_read_b32 v55, a179
    v_pk_mul_f32 v[48:49], v[48:49], v[80:81]
    v_pk_mul_f32 v[50:51], v[50:51], v[80:81]
    v_pk_mul_f32 v[52:53], v[52:53], v[80:81]
    v_mfma_f32_16x16x32_bf16 v[12:15], v[68:71], a[100:103], v[12:15]
    s_waitcnt vmcnt(9) lgkmcnt(4)
    v_pk_mul_f32 v[54:55], v[54:55], v[80:81]
    v_cvt_pk_bf16_f32 v60, v48, v49
    v_cvt_pk_bf16_f32 v61, v50, v51
    v_cvt_pk_bf16_f32 v62, v52, v53
    v_cvt_pk_bf16_f32 v63, v54, v55
    v_mfma_f32_16x16x32_bf16 v[0:3], v[72:75], a[8:11], v[0:3]
    ds_read_b128 v[68:71], v89 offset:256
    v_accvgpr_read_b32 v120, a132
    v_accvgpr_read_b32 v121, a133
    v_permlane16_swap_b32 v60, v62
    v_permlane16_swap_b32 v61, v63
    v_accvgpr_read_b32 v122, a134
    v_mfma_f32_16x16x32_bf16 v[4:7], v[72:75], a[40:43], v[4:7]
    v_accvgpr_read_b32 v123, a135
    ds_write_b128 v116, v[60:63] offset:8192
    v_accvgpr_read_b32 v124, a148
    v_accvgpr_read_b32 v125, a149
    v_accvgpr_read_b32 v126, a150
    v_mfma_f32_16x16x32_bf16 v[8:11], v[72:75], a[72:75], v[8:11]
    v_accvgpr_read_b32 v127, a151
    v_pk_mul_f32 v[120:121], v[120:121], v[82:83]
    v_pk_mul_f32 v[122:123], v[122:123], v[82:83]
    v_pk_mul_f32 v[124:125], v[124:125], v[82:83]
    v_pk_mul_f32 v[126:127], v[126:127], v[82:83]
    v_mfma_f32_16x16x32_bf16 v[12:15], v[72:75], a[104:107], v[12:15]
    s_waitcnt vmcnt(8) lgkmcnt(5)
    v_cvt_pk_bf16_f32 v56, v120, v121
    s_add_u32 s52, s40, 16384
    buffer_store_dwordx4 v[136:139], v109, s[20:23], s52 offen
    v_cvt_pk_bf16_f32 v57, v122, v123
    v_cvt_pk_bf16_f32 v58, v124, v125
    v_mfma_f32_16x16x32_bf16 v[0:3], v[76:79], a[12:15], v[0:3]
    ds_read_b128 v[72:75], v90 offset:256
    v_cvt_pk_bf16_f32 v59, v126, v127
    v_accvgpr_read_b32 v48, a164
    v_accvgpr_read_b32 v49, a165
    v_permlane16_swap_b32 v56, v58
    v_permlane16_swap_b32 v57, v59
    v_mfma_f32_16x16x32_bf16 v[4:7], v[76:79], a[44:47], v[4:7]
    v_accvgpr_read_b32 v50, a166
    v_accvgpr_read_b32 v51, a167
    ds_write_b128 v115, v[56:59] offset:10240
    v_accvgpr_read_b32 v52, a180
    v_accvgpr_read_b32 v53, a181
    v_mfma_f32_16x16x32_bf16 v[8:11], v[76:79], a[76:79], v[8:11]
    v_accvgpr_read_b32 v54, a182
    v_accvgpr_read_b32 v55, a183
    v_pk_mul_f32 v[48:49], v[48:49], v[82:83]
    v_pk_mul_f32 v[50:51], v[50:51], v[82:83]
    v_pk_mul_f32 v[52:53], v[52:53], v[82:83]
    v_mfma_f32_16x16x32_bf16 v[12:15], v[76:79], a[108:111], v[12:15]
    s_waitcnt vmcnt(8) lgkmcnt(5)
    v_pk_mul_f32 v[54:55], v[54:55], v[82:83]
    v_cvt_pk_bf16_f32 v60, v48, v49
    v_cvt_pk_bf16_f32 v61, v50, v51
    v_cvt_pk_bf16_f32 v62, v52, v53
    v_mfma_f32_16x16x32_bf16 v[0:3], v[64:67], a[16:19], v[0:3]
    ds_read_b128 v[76:79], v91 offset:256
    v_cvt_pk_bf16_f32 v63, v54, v55
    v_accvgpr_read_b32 v120, a136
    v_accvgpr_read_b32 v121, a137
    v_permlane16_swap_b32 v60, v62
    v_permlane16_swap_b32 v61, v63
    v_mfma_f32_16x16x32_bf16 v[4:7], v[64:67], a[48:51], v[4:7]
    v_accvgpr_read_b32 v122, a138
    v_accvgpr_read_b32 v123, a139
    ds_write_b128 v116, v[60:63] offset:10240
    v_accvgpr_read_b32 v124, a152
    v_accvgpr_read_b32 v125, a153
    v_mfma_f32_16x16x32_bf16 v[8:11], v[64:67], a[80:83], v[8:11]
    v_accvgpr_read_b32 v126, a154
    v_accvgpr_read_b32 v127, a155
    v_pk_mul_f32 v[120:121], v[120:121], v[84:85]
    v_pk_mul_f32 v[122:123], v[122:123], v[84:85]
    v_pk_mul_f32 v[124:125], v[124:125], v[84:85]
    v_mfma_f32_16x16x32_bf16 v[12:15], v[64:67], a[112:115], v[12:15]
    s_waitcnt vmcnt(7) lgkmcnt(5)
    v_pk_mul_f32 v[126:127], v[126:127], v[84:85]
    v_cvt_pk_bf16_f32 v56, v120, v121
    v_cvt_pk_bf16_f32 v57, v122, v123
    v_cvt_pk_bf16_f32 v58, v124, v125
    v_cvt_pk_bf16_f32 v59, v126, v127
    v_mfma_f32_16x16x32_bf16 v[0:3], v[68:71], a[20:23], v[0:3]
    ds_read_b128 v[64:67], v88 offset:8192
    v_accvgpr_read_b32 v48, a168
    v_accvgpr_read_b32 v49, a169
    v_permlane16_swap_b32 v56, v58
    v_permlane16_swap_b32 v57, v59
    v_accvgpr_read_b32 v50, a170
    v_mfma_f32_16x16x32_bf16 v[4:7], v[68:71], a[52:55], v[4:7]
    v_accvgpr_read_b32 v51, a171
    ds_write_b128 v115, v[56:59] offset:12288
    v_accvgpr_read_b32 v52, a184
    s_add_u32 s52, s40, 16384
    buffer_store_dwordx4 v[168:171], v109, s[20:23], s52 offen offset:64
    v_mfma_f32_16x16x32_bf16 v[8:11], v[68:71], a[84:87], v[8:11]
    v_accvgpr_read_b32 v53, a185
    v_accvgpr_read_b32 v54, a186
    v_accvgpr_read_b32 v55, a187
    v_pk_mul_f32 v[48:49], v[48:49], v[84:85]
    v_pk_mul_f32 v[50:51], v[50:51], v[84:85]
    v_mfma_f32_16x16x32_bf16 v[12:15], v[68:71], a[116:119], v[12:15]
    s_waitcnt vmcnt(7) lgkmcnt(5)
    v_pk_mul_f32 v[52:53], v[52:53], v[84:85]
    v_pk_mul_f32 v[54:55], v[54:55], v[84:85]
    v_cvt_pk_bf16_f32 v60, v48, v49
    v_cvt_pk_bf16_f32 v61, v50, v51
    v_cvt_pk_bf16_f32 v62, v52, v53
    v_mfma_f32_16x16x32_bf16 v[0:3], v[72:75], a[24:27], v[0:3]
    ds_read_b128 v[68:71], v89 offset:8192
    v_cvt_pk_bf16_f32 v63, v54, v55
    v_accvgpr_read_b32 v120, a140
    v_accvgpr_read_b32 v121, a141
    v_permlane16_swap_b32 v60, v62
    v_permlane16_swap_b32 v61, v63
    v_mfma_f32_16x16x32_bf16 v[4:7], v[72:75], a[56:59], v[4:7]
    v_accvgpr_read_b32 v122, a142
    v_accvgpr_read_b32 v123, a143
    ds_write_b128 v116, v[60:63] offset:12288
    v_accvgpr_read_b32 v124, a156
    v_accvgpr_read_b32 v125, a157
    v_mfma_f32_16x16x32_bf16 v[8:11], v[72:75], a[88:91], v[8:11]
    v_accvgpr_read_b32 v126, a158
    v_accvgpr_read_b32 v127, a159
    v_pk_mul_f32 v[120:121], v[120:121], v[86:87]
    v_pk_mul_f32 v[122:123], v[122:123], v[86:87]
    v_pk_mul_f32 v[124:125], v[124:125], v[86:87]
    v_mfma_f32_16x16x32_bf16 v[12:15], v[72:75], a[120:123], v[12:15]
    s_waitcnt vmcnt(6) lgkmcnt(5)
    v_pk_mul_f32 v[126:127], v[126:127], v[86:87]
    v_cvt_pk_bf16_f32 v56, v120, v121
    v_cvt_pk_bf16_f32 v57, v122, v123
    v_cvt_pk_bf16_f32 v58, v124, v125
    v_cvt_pk_bf16_f32 v59, v126, v127
    v_mfma_f32_16x16x32_bf16 v[0:3], v[76:79], a[28:31], v[0:3]
    ds_read_b128 v[72:75], v90 offset:8192
    v_accvgpr_read_b32 v48, a172
    v_accvgpr_read_b32 v49, a173
    v_permlane16_swap_b32 v56, v58
    v_permlane16_swap_b32 v57, v59
    v_accvgpr_read_b32 v50, a174
    v_mfma_f32_16x16x32_bf16 v[4:7], v[76:79], a[60:63], v[4:7]
    v_accvgpr_read_b32 v51, a175
    ds_write_b128 v115, v[56:59] offset:14336
    v_accvgpr_read_b32 v52, a188
    v_accvgpr_read_b32 v53, a189
    v_accvgpr_read_b32 v54, a190
    v_mfma_f32_16x16x32_bf16 v[8:11], v[76:79], a[92:95], v[8:11]
    v_accvgpr_read_b32 v55, a191
    v_pk_mul_f32 v[48:49], v[48:49], v[86:87]
    v_pk_mul_f32 v[50:51], v[50:51], v[86:87]
    v_pk_mul_f32 v[52:53], v[52:53], v[86:87]
    v_pk_mul_f32 v[54:55], v[54:55], v[86:87]
    v_mfma_f32_16x16x32_bf16 v[12:15], v[76:79], a[124:127], v[12:15]
    s_waitcnt lgkmcnt(5)
    v_cvt_pk_bf16_f32 v60, v48, v49
    v_cvt_pk_bf16_f32 v61, v50, v51
    v_cvt_pk_bf16_f32 v62, v52, v53
    v_cvt_pk_bf16_f32 v63, v54, v55
    v_mfma_f32_16x16x32_bf16 v[16:19], v[64:67], a[0:3], 0
    ds_read_b128 v[76:79], v91 offset:8192
    v_accvgpr_read_b32 v120, a192
    v_accvgpr_read_b32 v121, a193
    v_permlane16_swap_b32 v60, v62
    v_permlane16_swap_b32 v61, v63
    s_add_u32 s52, s40, 24576
    v_mfma_f32_16x16x32_bf16 v[20:23], v[64:67], a[32:35], 0
    buffer_store_dwordx4 v[140:143], v109, s[20:23], s52 offen
    v_accvgpr_read_b32 v122, a194
    v_accvgpr_read_b32 v123, a195
    ds_write_b128 v116, v[60:63] offset:14336
    v_accvgpr_read_b32 v124, a208
    v_mfma_f32_16x16x32_bf16 v[24:27], v[64:67], a[64:67], 0
    v_accvgpr_read_b32 v125, a209
    v_accvgpr_read_b32 v126, a210
    v_accvgpr_read_b32 v127, a211
    v_pk_mul_f32 v[120:121], v[120:121], v[80:81]
    v_pk_mul_f32 v[122:123], v[122:123], v[80:81]
    v_mfma_f32_16x16x32_bf16 v[28:31], v[64:67], a[96:99], 0
    s_waitcnt lgkmcnt(5)
    v_pk_mul_f32 v[124:125], v[124:125], v[80:81]
    v_pk_mul_f32 v[126:127], v[126:127], v[80:81]
    v_cvt_pk_bf16_f32 v56, v120, v121
    v_cvt_pk_bf16_f32 v57, v122, v123
    v_cvt_pk_bf16_f32 v58, v124, v125
    v_mfma_f32_16x16x32_bf16 v[16:19], v[68:71], a[4:7], v[16:19]
    ds_read_b128 v[64:67], v88 offset:8448
    v_cvt_pk_bf16_f32 v59, v126, v127
    v_accvgpr_read_b32 v48, a224
    v_accvgpr_read_b32 v49, a225
    v_permlane16_swap_b32 v56, v58
    v_permlane16_swap_b32 v57, v59
    v_mfma_f32_16x16x32_bf16 v[20:23], v[68:71], a[36:39], v[20:23]
    v_accvgpr_read_b32 v50, a226
    v_accvgpr_read_b32 v51, a227
    ds_write_b128 v115, v[56:59] offset:16384
    v_accvgpr_read_b32 v52, a240
    v_accvgpr_read_b32 v53, a241
    v_mfma_f32_16x16x32_bf16 v[24:27], v[68:71], a[68:71], v[24:27]
    v_accvgpr_read_b32 v54, a242
    v_accvgpr_read_b32 v55, a243
    v_pk_mul_f32 v[48:49], v[48:49], v[80:81]
    v_pk_mul_f32 v[50:51], v[50:51], v[80:81]
    v_pk_mul_f32 v[52:53], v[52:53], v[80:81]
    v_mfma_f32_16x16x32_bf16 v[28:31], v[68:71], a[100:103], v[28:31]
    s_waitcnt lgkmcnt(5)
    v_pk_mul_f32 v[54:55], v[54:55], v[80:81]
    v_cvt_pk_bf16_f32 v60, v48, v49
    v_cvt_pk_bf16_f32 v61, v50, v51
    v_cvt_pk_bf16_f32 v62, v52, v53
    v_mfma_f32_16x16x32_bf16 v[16:19], v[72:75], a[8:11], v[16:19]
    ds_read_b128 v[68:71], v89 offset:8448
    v_cvt_pk_bf16_f32 v63, v54, v55
    v_accvgpr_read_b32 v120, a196
    v_accvgpr_read_b32 v121, a197
    v_permlane16_swap_b32 v60, v62
    v_permlane16_swap_b32 v61, v63
    v_mfma_f32_16x16x32_bf16 v[20:23], v[72:75], a[40:43], v[20:23]
    v_accvgpr_read_b32 v122, a198
    v_accvgpr_read_b32 v123, a199
    ds_write_b128 v116, v[60:63] offset:16384
    v_accvgpr_read_b32 v124, a212
    v_accvgpr_read_b32 v125, a213
    v_mfma_f32_16x16x32_bf16 v[24:27], v[72:75], a[72:75], v[24:27]
    v_accvgpr_read_b32 v126, a214
    v_accvgpr_read_b32 v127, a215
    v_pk_mul_f32 v[120:121], v[120:121], v[82:83]
    v_pk_mul_f32 v[122:123], v[122:123], v[82:83]
    v_pk_mul_f32 v[124:125], v[124:125], v[82:83]
    v_mfma_f32_16x16x32_bf16 v[28:31], v[72:75], a[104:107], v[28:31]
    s_waitcnt lgkmcnt(5)
    v_pk_mul_f32 v[126:127], v[126:127], v[82:83]
    v_cvt_pk_bf16_f32 v56, v120, v121
    v_cvt_pk_bf16_f32 v57, v122, v123
    v_cvt_pk_bf16_f32 v58, v124, v125
    v_cvt_pk_bf16_f32 v59, v126, v127
    v_mfma_f32_16x16x32_bf16 v[16:19], v[76:79], a[12:15], v[16:19]
    ds_read_b128 v[72:75], v90 offset:8448
    v_accvgpr_read_b32 v48, a228
    v_accvgpr_read_b32 v49, a229
    v_permlane16_swap_b32 v56, v58
    v_permlane16_swap_b32 v57, v59
    v_accvgpr_read_b32 v50, a230
    v_mfma_f32_16x16x32_bf16 v[20:23], v[76:79], a[44:47], v[20:23]
    v_accvgpr_read_b32 v51, a231
    ds_write_b128 v115, v[56:59] offset:18432
    v_accvgpr_read_b32 v52, a244
    v_accvgpr_read_b32 v53, a245
    v_accvgpr_read_b32 v54, a246
    v_mfma_f32_16x16x32_bf16 v[24:27], v[76:79], a[76:79], v[24:27]
    v_accvgpr_read_b32 v55, a247
    v_pk_mul_f32 v[48:49], v[48:49], v[82:83]
    v_pk_mul_f32 v[50:51], v[50:51], v[82:83]
    v_pk_mul_f32 v[52:53], v[52:53], v[82:83]
    v_pk_mul_f32 v[54:55], v[54:55], v[82:83]
    v_mfma_f32_16x16x32_bf16 v[28:31], v[76:79], a[108:111], v[28:31]
    s_waitcnt lgkmcnt(5)
    v_cvt_pk_bf16_f32 v60, v48, v49
    v_cvt_pk_bf16_f32 v61, v50, v51
    v_cvt_pk_bf16_f32 v62, v52, v53
    v_cvt_pk_bf16_f32 v63, v54, v55
    v_mfma_f32_16x16x32_bf16 v[16:19], v[64:67], a[16:19], v[16:19]
    ds_read_b128 v[76:79], v91 offset:8448
    v_accvgpr_read_b32 v120, a200
    v_accvgpr_read_b32 v121, a201
    s_add_u32 s52, s40, 24576
    buffer_store_dwordx4 v[172:175], v109, s[20:23], s52 offen offset:64
    v_permlane16_swap_b32 v60, v62
    v_mfma_f32_16x16x32_bf16 v[20:23], v[64:67], a[48:51], v[20:23]
    v_permlane16_swap_b32 v61, v63
    v_accvgpr_read_b32 v122, a202
    v_accvgpr_read_b32 v123, a203
    ds_write_b128 v116, v[60:63] offset:18432
    v_accvgpr_read_b32 v124, a216
    v_mfma_f32_16x16x32_bf16 v[24:27], v[64:67], a[80:83], v[24:27]
    v_accvgpr_read_b32 v125, a217
    v_accvgpr_read_b32 v126, a218
    v_accvgpr_read_b32 v127, a219
    v_pk_mul_f32 v[120:121], v[120:121], v[84:85]
    v_pk_mul_f32 v[122:123], v[122:123], v[84:85]
    v_mfma_f32_16x16x32_bf16 v[28:31], v[64:67], a[112:115], v[28:31]
    s_waitcnt lgkmcnt(5)
    v_pk_mul_f32 v[124:125], v[124:125], v[84:85]
    v_pk_mul_f32 v[126:127], v[126:127], v[84:85]
    v_cvt_pk_bf16_f32 v56, v120, v121
    v_cvt_pk_bf16_f32 v57, v122, v123
    v_cvt_pk_bf16_f32 v58, v124, v125
    v_mfma_f32_16x16x32_bf16 v[16:19], v[68:71], a[20:23], v[16:19]
    v_cvt_pk_bf16_f32 v59, v126, v127
    v_accvgpr_read_b32 v48, a232
    v_accvgpr_read_b32 v49, a233
    v_permlane16_swap_b32 v56, v58
    v_permlane16_swap_b32 v57, v59
    v_mfma_f32_16x16x32_bf16 v[20:23], v[68:71], a[52:55], v[20:23]
    v_accvgpr_read_b32 v50, a234
    v_accvgpr_read_b32 v51, a235
    ds_write_b128 v115, v[56:59] offset:20480
    v_accvgpr_read_b32 v52, a248
    v_accvgpr_read_b32 v53, a249
    v_mfma_f32_16x16x32_bf16 v[24:27], v[68:71], a[84:87], v[24:27]
    v_accvgpr_read_b32 v54, a250
    v_accvgpr_read_b32 v55, a251
    v_pk_mul_f32 v[48:49], v[48:49], v[84:85]
    v_pk_mul_f32 v[50:51], v[50:51], v[84:85]
    v_pk_mul_f32 v[52:53], v[52:53], v[84:85]
    v_mfma_f32_16x16x32_bf16 v[28:31], v[68:71], a[116:119], v[28:31]
    s_waitcnt vmcnt(20) lgkmcnt(0)
    s_barrier
    v_pk_mul_f32 v[54:55], v[54:55], v[84:85]
    v_cvt_pk_bf16_f32 v60, v48, v49
    v_cvt_pk_bf16_f32 v61, v50, v51
    v_cvt_pk_bf16_f32 v62, v52, v53
    v_mfma_f32_16x16x32_bf16 v[16:19], v[72:75], a[24:27], v[16:19]
    s_mov_b32 m0, s34
    v_cvt_pk_bf16_f32 v63, v54, v55
    v_accvgpr_read_b32 v120, a204
    v_accvgpr_read_b32 v121, a205
    v_permlane16_swap_b32 v60, v62
    v_permlane16_swap_b32 v61, v63
    v_mfma_f32_16x16x32_bf16 v[20:23], v[72:75], a[56:59], v[20:23]
    buffer_load_dwordx4 v100, s[12:15], s32 offen lds
    v_accvgpr_read_b32 v122, a206
    v_accvgpr_read_b32 v123, a207
    ds_write_b128 v116, v[60:63] offset:20480
    v_accvgpr_read_b32 v124, a220
    v_accvgpr_read_b32 v125, a221
    v_mfma_f32_16x16x32_bf16 v[24:27], v[72:75], a[88:91], v[24:27]
    buffer_load_dwordx4 v101, s[12:15], s32 offen offset:1024 lds
    v_accvgpr_read_b32 v126, a222
    v_accvgpr_read_b32 v127, a223
    v_pk_mul_f32 v[120:121], v[120:121], v[86:87]
    v_pk_mul_f32 v[122:123], v[122:123], v[86:87]
    v_pk_mul_f32 v[124:125], v[124:125], v[86:87]
    v_mfma_f32_16x16x32_bf16 v[28:31], v[72:75], a[120:123], v[28:31]
    s_waitcnt lgkmcnt(3)
    buffer_load_dwordx4 v102, s[12:15], s32 offen offset:2048 lds
    v_pk_mul_f32 v[126:127], v[126:127], v[86:87]
    v_cvt_pk_bf16_f32 v56, v120, v121
    v_cvt_pk_bf16_f32 v57, v122, v123
    v_cvt_pk_bf16_f32 v58, v124, v125
    v_cvt_pk_bf16_f32 v59, v126, v127
    v_mfma_f32_16x16x32_bf16 v[16:19], v[76:79], a[28:31], v[16:19]
    buffer_load_dwordx4 v103, s[12:15], s32 offen offset:3072 lds
    v_accvgpr_read_b32 v48, a236
    v_accvgpr_read_b32 v49, a237
    v_permlane16_swap_b32 v56, v58
    v_permlane16_swap_b32 v57, v59
    v_accvgpr_read_b32 v50, a238
    v_mfma_f32_16x16x32_bf16 v[20:23], v[76:79], a[60:63], v[20:23]
    v_accvgpr_read_b32 v51, a239
    ds_write_b128 v115, v[56:59] offset:22528
    v_accvgpr_read_b32 v52, a252
    v_accvgpr_read_b32 v53, a253
    v_accvgpr_read_b32 v54, a254
    v_mfma_f32_16x16x32_bf16 v[24:27], v[76:79], a[92:95], v[24:27]
    s_add_u32 s32, s32, 16384
    v_accvgpr_read_b32 v55, a255
    v_pk_mul_f32 v[48:49], v[48:49], v[86:87]
    v_pk_mul_f32 v[50:51], v[50:51], v[86:87]
    v_pk_mul_f32 v[52:53], v[52:53], v[86:87]
    v_pk_mul_f32 v[54:55], v[54:55], v[86:87]
    v_mfma_f32_16x16x32_bf16 v[28:31], v[76:79], a[124:127], v[28:31]
    v_cvt_pk_bf16_f32 v60, v48, v49
    v_cvt_pk_bf16_f32 v61, v50, v51
    v_cvt_pk_bf16_f32 v62, v52, v53
    v_cvt_pk_bf16_f32 v63, v54, v55
    s_nop 1
    v_permlane16_swap_b32 v60, v62
    v_permlane16_swap_b32 v61, v63
    s_nop 0
    ds_write_b128 v116, v[60:63] offset:22528
L_fe0_end:
    ds_read_b128 v[64:67], v88 offset:16384
    ds_read_b128 v[68:71], v89 offset:16384
    s_nop 3
    v_max3_f32 v84, v0, v1, v2
    v_max3_f32 v85, v4, v5, v6
    v_max3_f32 v86, v8, v9, v10
    v_max3_f32 v87, v12, v13, v14
    v_max3_f32 v84, v84, v3, v16
    v_max3_f32 v85, v85, v7, v20
    v_max3_f32 v86, v86, v11, v24
    v_max3_f32 v87, v87, v15, v28
    v_max3_f32 v84, v84, v17, v18
    v_max3_f32 v85, v85, v21, v22
    v_max3_f32 v86, v86, v25, v26
    v_max3_f32 v87, v87, v29, v30
    v_max_f32 v84, v84, v19
    v_max_f32 v85, v85, v23
    v_max_f32 v86, v86, v27
    v_max_f32 v87, v87, v31
    v_mov_b32 v120, v84
    v_mov_b32 v121, v85
    v_mov_b32 v122, v86
    v_mov_b32 v123, v87
    s_nop 1
    v_permlane16_swap_b32 v84, v120
    v_permlane16_swap_b32 v85, v121
    v_permlane16_swap_b32 v86, v122
    v_permlane16_swap_b32 v87, v123
    s_nop 1
    v_max_f32 v84, v84, v120
    v_max_f32 v85, v85, v121
    v_max_f32 v86, v86, v122
    v_max_f32 v87, v87, v123
    v_mov_b32 v120, v84
    v_mov_b32 v121, v85
    v_mov_b32 v122, v86
    v_mov_b32 v123, v87
    s_nop 1
    v_permlane32_swap_b32 v84, v120
    v_permlane32_swap_b32 v85, v121
    v_permlane32_swap_b32 v86, v122
    v_permlane32_swap_b32 v87, v123
    s_nop 1
    v_max_f32 v84, v84, v120
    v_max_f32 v85, v85, v121
    v_max_f32 v86, v86, v122
    v_max_f32 v87, v87, v123
    v_mul_f32 v84, s28, v84
    v_mul_f32 v85, s28, v85
    v_mul_f32 v86, s28, v86
    v_mul_f32 v87, s28, v87
    v_mov_b32 v80, 0
    v_mov_b32 v81, 0
    v_mov_b32 v82, 0
    v_mov_b32 v83, 0
    v_fma_f32 v0, v0, s28, -v84
    v_exp_f32 v0, v0
    s_nop 0
    v_add_f32 v80, v80, v0
    v_fma_f32 v1, v1, s28, -v84
    v_exp_f32 v1, v1
    v_fma_f32 v2, v2, s28, -v84
    v_exp_f32 v2, v2
    v_add_f32 v80, v80, v1
    v_add_f32 v80, v80, v2
    v_fma_f32 v3, v3, s28, -v84
    v_exp_f32 v3, v3
    v_fma_f32 v4, v4, s28, -v85
    v_add_f32 v80, v80, v3
    v_exp_f32 v4, v4
    s_nop 0
    v_add_f32 v81, v81, v4
    v_fma_f32 v7, v7, s28, -v85
    v_fma_f32 v6, v6, s28, -v85
    v_fma_f32 v5, v5, s28, -v85
    v_exp_f32 v5, v5
    v_exp_f32 v6, v6
    v_exp_f32 v7, v7
    v_add_f32 v81, v81, v5
    v_add_f32 v81, v81, v6
    v_add_f32 v81, v81, v7
    v_fma_f32 v8, v8, s28, -v86
    v_exp_f32 v8, v8
    v_fma_f32 v10, v10, s28, -v86
    v_fma_f32 v9, v9, s28, -v86
    v_exp_f32 v9, v9
    v_exp_f32 v10, v10
    v_fma_f32 v12, v12, s28, -v87
    v_fma_f32 v11, v11, s28, -v86
    v_exp_f32 v11, v11
    v_exp_f32 v12, v12
    v_add_f32 v82, v82, v8
    v_fma_f32 v13, v13, s28, -v87
    v_exp_f32 v13, v13
    v_add_f32 v82, v82, v9
    v_fma_f32 v14, v14, s28, -v87
    v_exp_f32 v14, v14
    v_add_f32 v82, v82, v10
    v_add_f32 v82, v82, v11
    v_add_f32 v83, v83, v12
    v_fma_f32 v15, v15, s28, -v87
    v_exp_f32 v15, v15
    v_add_f32 v83, v83, v13
    v_add_f32 v83, v83, v14
    v_add_f32 v83, v83, v15
    v_fma_f32 v16, v16, s28, -v84
    v_exp_f32 v16, v16
    v_fma_f32 v18, v18, s28, -v84
    v_fma_f32 v17, v17, s28, -v84
    v_exp_f32 v17, v17
    v_exp_f32 v18, v18
    v_add_f32 v80, v80, v16
    v_fma_f32 v19, v19, s28, -v84
    v_add_f32 v80, v80, v18
    v_exp_f32 v19, v19
    v_add_f32 v80, v80, v17
    v_fma_f32 v20, v20, s28, -v85
    v_exp_f32 v20, v20
    v_add_f32 v80, v80, v19
    v_fma_f32 v21, v21, s28, -v85
    v_exp_f32 v21, v21
    v_add_f32 v81, v81, v20
    v_add_f32 v81, v81, v21
    v_fma_f32 v23, v23, s28, -v85
    v_fma_f32 v22, v22, s28, -v85
    v_exp_f32 v22, v22
    v_exp_f32 v23, v23
    v_add_f32 v81, v81, v22
    v_add_f32 v81, v81, v23
    v_cvt_pk_bf16_f32 v34, v16, v17
    v_cvt_pk_bf16_f32 v35, v18, v19
    v_cvt_pk_bf16_f32 v32, v0, v1
    v_cvt_pk_bf16_f32 v33, v2, v3
    v_cvt_pk_bf16_f32 v36, v4, v5
    v_cvt_pk_bf16_f32 v37, v6, v7
    s_nop 0
    s_waitcnt lgkmcnt(0)
    s_add_u32 s43, s38, 128
    s_mov_b32 s58, 16384
    v_mfma_f32_16x16x32_bf16 v[0:3], v[64:67], a[0:3], 0
    ds_read_b128 v[72:75], v90 offset:16384
    v_cvt_pk_bf16_f32 v38, v20, v21
    v_mfma_f32_16x16x32_bf16 v[0:3], v[68:71], a[4:7], v[0:3]
    v_cvt_pk_bf16_f32 v40, v8, v9
    v_cvt_pk_bf16_f32 v41, v10, v11
    v_mfma_f32_16x16x32_bf16 v[4:7], v[64:67], a[32:35], 0
    ds_read_b128 v[76:79], v91 offset:16384
    v_cvt_pk_bf16_f32 v39, v22, v23
    v_mfma_f32_16x16x32_bf16 v[4:7], v[68:71], a[36:39], v[4:7]
    v_cvt_pk_bf16_f32 v44, v12, v13
    v_cvt_pk_bf16_f32 v45, v14, v15
    v_mfma_f32_16x16x32_bf16 v[8:11], v[64:67], a[64:67], 0
    s_mov_b32 m0, s37
    v_mfma_f32_16x16x32_bf16 v[8:11], v[68:71], a[68:71], v[8:11]
    v_fma_f32 v24, v24, s28, -v86
    v_mfma_f32_16x16x32_bf16 v[12:15], v[64:67], a[96:99], 0
    buffer_load_dwordx4 v104, s[16:19], s33 offen lds
    v_mfma_f32_16x16x32_bf16 v[12:15], v[68:71], a[100:103], v[12:15]
    s_waitcnt lgkmcnt(0)
    v_exp_f32 v24, v24
    v_mfma_f32_16x16x32_bf16 v[0:3], v[72:75], a[8:11], v[0:3]
    ds_read_b128 v[64:67], v88 offset:16640
    v_fma_f32 v25, v25, s28, -v86
    v_mfma_f32_16x16x32_bf16 v[0:3], v[76:79], a[12:15], v[0:3]
    v_exp_f32 v25, v25
    v_mfma_f32_16x16x32_bf16 v[4:7], v[72:75], a[40:43], v[4:7]
    ds_read_b128 v[68:71], v89 offset:16640
    v_cvt_pk_bf16_f32 v42, v24, v25
    v_mfma_f32_16x16x32_bf16 v[4:7], v[76:79], a[44:47], v[4:7]
    v_fma_f32 v26, v26, s28, -v86
    v_fma_f32 v27, v27, s28, -v86
    v_mfma_f32_16x16x32_bf16 v[8:11], v[72:75], a[72:75], v[8:11]
    v_exp_f32 v26, v26
    v_mfma_f32_16x16x32_bf16 v[8:11], v[76:79], a[76:79], v[8:11]
    v_add_f32 v82, v82, v24
    v_add_f32 v82, v82, v25
    v_mfma_f32_16x16x32_bf16 v[12:15], v[72:75], a[104:107], v[12:15]
    buffer_load_dwordx4 v105, s[16:19], s33 offen offset:1024 lds
    v_mfma_f32_16x16x32_bf16 v[12:15], v[76:79], a[108:111], v[12:15]
    s_waitcnt lgkmcnt(0)
    v_exp_f32 v27, v27
    v_mfma_f32_16x16x32_bf16 v[0:3], v[64:67], a[16:19], v[0:3]
    ds_read_b128 v[72:75], v90 offset:16640
    v_cvt_pk_bf16_f32 v43, v26, v27
    v_mfma_f32_16x16x32_bf16 v[0:3], v[68:71], a[20:23], v[0:3]
    v_add_f32 v82, v82, v26
    v_add_f32 v82, v82, v27
    v_mfma_f32_16x16x32_bf16 v[4:7], v[64:67], a[48:51], v[4:7]
    ds_read_b128 v[76:79], v91 offset:16640
    v_fma_f32 v28, v28, s28, -v87
    v_mfma_f32_16x16x32_bf16 v[4:7], v[68:71], a[52:55], v[4:7]
    v_exp_f32 v28, v28
    v_mfma_f32_16x16x32_bf16 v[8:11], v[64:67], a[80:83], v[8:11]
    v_fma_f32 v29, v29, s28, -v87
    v_add_f32 v83, v83, v28
    v_mfma_f32_16x16x32_bf16 v[8:11], v[68:71], a[84:87], v[8:11]
    v_exp_f32 v29, v29
    v_mfma_f32_16x16x32_bf16 v[12:15], v[64:67], a[112:115], v[12:15]
    buffer_load_dwordx4 v106, s[16:19], s33 offen offset:2048 lds
    v_mfma_f32_16x16x32_bf16 v[12:15], v[68:71], a[116:119], v[12:15]
    s_waitcnt lgkmcnt(0)
    v_add_f32 v83, v83, v29
    v_cvt_pk_bf16_f32 v46, v28, v29
    v_mfma_f32_16x16x32_bf16 v[0:3], v[72:75], a[24:27], v[0:3]
    ds_read_b128 v[64:67], v88 offset:24576
    v_fma_f32 v30, v30, s28, -v87
    v_mfma_f32_16x16x32_bf16 v[0:3], v[76:79], a[28:31], v[0:3]
    v_exp_f32 v30, v30
    v_mfma_f32_16x16x32_bf16 v[4:7], v[72:75], a[56:59], v[4:7]
    ds_read_b128 v[68:71], v89 offset:24576
    v_fma_f32 v31, v31, s28, -v87
    v_mfma_f32_16x16x32_bf16 v[4:7], v[76:79], a[60:63], v[4:7]
    v_exp_f32 v31, v31
    v_mfma_f32_16x16x32_bf16 v[8:11], v[72:75], a[88:91], v[8:11]
    v_add_f32 v83, v83, v30
    v_cvt_pk_bf16_f32 v47, v30, v31
    v_mfma_f32_16x16x32_bf16 v[8:11], v[76:79], a[92:95], v[8:11]
    v_mfma_f32_16x16x32_bf16 v[12:15], v[72:75], a[120:123], v[12:15]
    buffer_load_dwordx4 v107, s[16:19], s33 offen offset:3072 lds
    v_mfma_f32_16x16x32_bf16 v[12:15], v[76:79], a[124:127], v[12:15]
    s_waitcnt lgkmcnt(0)
    v_mfma_f32_16x16x32_bf16 v[16:19], v[64:67], a[0:3], 0
    s_add_u32 s33, s33, 16384
    ds_read_b128 v[72:75], v90 offset:24576
    v_add_f32 v83, v83, v31
    v_mfma_f32_16x16x32_bf16 v[16:19], v[68:71], a[4:7], v[16:19]
    v_mfma_f32_16x16x32_bf16 v[20:23], v[64:67], a[32:35], 0
    ds_read_b128 v[76:79], v91 offset:24576
    v_fma_f32 v0, v0, s28, -v84
    v_mfma_f32_16x16x32_bf16 v[20:23], v[68:71], a[36:39], v[20:23]
    v_mfma_f32_16x16x32_bf16 v[24:27], v[64:67], a[64:67], 0
    v_mfma_f32_16x16x32_bf16 v[24:27], v[68:71], a[68:71], v[24:27]
    v_mfma_f32_16x16x32_bf16 v[28:31], v[64:67], a[96:99], 0
    v_exp_f32 v0, v0
    v_mfma_f32_16x16x32_bf16 v[28:31], v[68:71], a[100:103], v[28:31]
    s_waitcnt lgkmcnt(0)
    v_add_f32 v80, v80, v0
    v_mfma_f32_16x16x32_bf16 v[16:19], v[72:75], a[8:11], v[16:19]
    ds_read_b128 v[64:67], v88 offset:24832
    v_fma_f32 v1, v1, s28, -v84
    v_mfma_f32_16x16x32_bf16 v[16:19], v[76:79], a[12:15], v[16:19]
    v_exp_f32 v1, v1
    v_mfma_f32_16x16x32_bf16 v[20:23], v[72:75], a[40:43], v[20:23]
    ds_read_b128 v[68:71], v89 offset:24832
    v_fma_f32 v2, v2, s28, -v84
    v_mfma_f32_16x16x32_bf16 v[20:23], v[76:79], a[44:47], v[20:23]
    v_mfma_f32_16x16x32_bf16 v[24:27], v[72:75], a[72:75], v[24:27]
    v_mfma_f32_16x16x32_bf16 v[24:27], v[76:79], a[76:79], v[24:27]
    v_exp_f32 v2, v2
    v_mfma_f32_16x16x32_bf16 v[28:31], v[72:75], a[104:107], v[28:31]
    v_add_f32 v80, v80, v1
    v_mfma_f32_16x16x32_bf16 v[28:31], v[76:79], a[108:111], v[28:31]
    s_waitcnt lgkmcnt(0)
    v_add_f32 v80, v80, v2
    v_mfma_f32_16x16x32_bf16 v[16:19], v[64:67], a[16:19], v[16:19]
    ds_read_b128 v[72:75], v90 offset:24832
    v_fma_f32 v3, v3, s28, -v84
    v_mfma_f32_16x16x32_bf16 v[16:19], v[68:71], a[20:23], v[16:19]
    v_exp_f32 v3, v3
    v_mfma_f32_16x16x32_bf16 v[20:23], v[64:67], a[48:51], v[20:23]
    ds_read_b128 v[76:79], v91 offset:24832
    v_fma_f32 v4, v4, s28, -v85
    v_mfma_f32_16x16x32_bf16 v[20:23], v[68:71], a[52:55], v[20:23]
    v_add_f32 v80, v80, v3
    v_mfma_f32_16x16x32_bf16 v[24:27], v[64:67], a[80:83], v[24:27]
    v_mfma_f32_16x16x32_bf16 v[24:27], v[68:71], a[84:87], v[24:27]
    v_exp_f32 v4, v4
    v_mfma_f32_16x16x32_bf16 v[28:31], v[64:67], a[112:115], v[28:31]
    v_mfma_f32_16x16x32_bf16 v[28:31], v[68:71], a[116:119], v[28:31]
    s_waitcnt vmcnt(24) lgkmcnt(0)
    s_barrier
    v_mfma_f32_16x16x32_bf16 v[16:19], v[72:75], a[24:27], v[16:19]
    ds_read_b64_tr_b16 v[64:65], v92 offset:32768
    v_add_f32 v81, v81, v4
    v_mfma_f32_16x16x32_bf16 v[16:19], v[76:79], a[28:31], v[16:19]
    ds_read_b64_tr_b16 v[66:67], v92 offset:40960
    v_fma_f32 v7, v7, s28, -v85
    v_mfma_f32_16x16x32_bf16 v[20:23], v[72:75], a[56:59], v[20:23]
    ds_read_b64_tr_b16 v[68:69], v93 offset:32768
    v_fma_f32 v6, v6, s28, -v85
    v_mfma_f32_16x16x32_bf16 v[20:23], v[76:79], a[60:63], v[20:23]
    ds_read_b64_tr_b16 v[70:71], v93 offset:40960
    v_fma_f32 v5, v5, s28, -v85
    v_mfma_f32_16x16x32_bf16 v[24:27], v[72:75], a[88:91], v[24:27]
    v_exp_f32 v5, v5
    v_mfma_f32_16x16x32_bf16 v[24:27], v[76:79], a[92:95], v[24:27]
    v_exp_f32 v6, v6
    v_mfma_f32_16x16x32_bf16 v[28:31], v[72:75], a[120:123], v[28:31]
    v_mfma_f32_16x16x32_bf16 v[28:31], v[76:79], a[124:127], v[28:31]
    s_waitcnt lgkmcnt(2)
    v_exp_f32 v7, v7
    v_mfma_f32_16x16x32_bf16 v[128:131], v[64:67], v[32:35], 0
    ds_read_b64_tr_b16 v[72:73], v94 offset:32768
    v_add_f32 v81, v81, v5
    v_mfma_f32_16x16x32_bf16 v[132:135], v[64:67], v[36:39], 0
    ds_read_b64_tr_b16 v[74:75], v94 offset:40960
    v_add_f32 v81, v81, v6
    v_mfma_f32_16x16x32_bf16 v[136:139], v[64:67], v[40:43], 0
    ds_read_b64_tr_b16 v[76:77], v95 offset:32768
    v_add_f32 v81, v81, v7
    v_mfma_f32_16x16x32_bf16 v[140:143], v[64:67], v[44:47], 0
    s_waitcnt lgkmcnt(3)
    ds_read_b64_tr_b16 v[78:79], v95 offset:40960
    v_mfma_f32_16x16x32_bf16 v[144:147], v[68:71], v[32:35], 0
    s_mov_b32 m0, s35
    ds_read_b64_tr_b16 v[64:65], v96 offset:32768
    v_mfma_f32_16x16x32_bf16 v[148:151], v[68:71], v[36:39], 0
    ds_read_b64_tr_b16 v[66:67], v96 offset:40960
    v_fma_f32 v8, v8, s28, -v86
    v_mfma_f32_16x16x32_bf16 v[152:155], v[68:71], v[40:43], 0
    buffer_load_dwordx4 v100, s[12:15], s32 offen lds
    v_mfma_f32_16x16x32_bf16 v[156:159], v[68:71], v[44:47], 0
    s_waitcnt lgkmcnt(4)
    v_exp_f32 v8, v8
    v_mfma_f32_16x16x32_bf16 v[160:163], v[72:75], v[32:35], 0
    ds_read_b64_tr_b16 v[68:69], v97 offset:32768
    v_fma_f32 v10, v10, s28, -v86
    v_mfma_f32_16x16x32_bf16 v[164:167], v[72:75], v[36:39], 0
    ds_read_b64_tr_b16 v[70:71], v97 offset:40960
    v_fma_f32 v9, v9, s28, -v86
    v_mfma_f32_16x16x32_bf16 v[168:171], v[72:75], v[40:43], 0
    v_exp_f32 v9, v9
    v_mfma_f32_16x16x32_bf16 v[172:175], v[72:75], v[44:47], 0
    s_waitcnt lgkmcnt(4)
    v_exp_f32 v10, v10
    v_mfma_f32_16x16x32_bf16 v[176:179], v[76:79], v[32:35], 0
    ds_read_b64_tr_b16 v[72:73], v98 offset:32768
    v_fma_f32 v12, v12, s28, -v87
    v_mfma_f32_16x16x32_bf16 v[180:183], v[76:79], v[36:39], 0
    ds_read_b64_tr_b16 v[74:75], v98 offset:40960
    v_fma_f32 v11, v11, s28, -v86
    v_mfma_f32_16x16x32_bf16 v[184:187], v[76:79], v[40:43], 0
    v_exp_f32 v11, v11
    v_mfma_f32_16x16x32_bf16 v[188:191], v[76:79], v[44:47], 0
    s_waitcnt lgkmcnt(4)
    v_exp_f32 v12, v12
    v_mfma_f32_16x16x32_bf16 v[192:195], v[64:67], v[32:35], 0
    ds_read_b64_tr_b16 v[76:77], v99 offset:32768
    v_add_f32 v82, v82, v8
    v_mfma_f32_16x16x32_bf16 v[196:199], v[64:67], v[36:39], 0
    ds_read_b64_tr_b16 v[78:79], v99 offset:40960
    v_fma_f32 v13, v13, s28, -v87
    v_mfma_f32_16x16x32_bf16 v[200:203], v[64:67], v[40:43], 0
    buffer_load_dwordx4 v101, s[12:15], s32 offen offset:1024 lds
    v_mfma_f32_16x16x32_bf16 v[204:207], v[64:67], v[44:47], 0
    s_waitcnt lgkmcnt(4)
    v_exp_f32 v13, v13
    v_mfma_f32_16x16x32_bf16 v[208:211], v[68:71], v[32:35], 0
    ds_read_b64_tr_b16 v[64:65], v92 offset:33024
    v_add_f32 v82, v82, v9
    v_mfma_f32_16x16x32_bf16 v[212:215], v[68:71], v[36:39], 0
    ds_read_b64_tr_b16 v[66:67], v92 offset:41216
    v_fma_f32 v14, v14, s28, -v87
    v_mfma_f32_16x16x32_bf16 v[216:219], v[68:71], v[40:43], 0
    v_exp_f32 v14, v14
    v_mfma_f32_16x16x32_bf16 v[220:223], v[68:71], v[44:47], 0
    s_waitcnt lgkmcnt(4)
    v_add_f32 v82, v82, v10
    v_add_f32 v82, v82, v11
    v_mfma_f32_16x16x32_bf16 v[224:227], v[72:75], v[32:35], 0
    ds_read_b64_tr_b16 v[68:69], v93 offset:33024
    v_add_f32 v83, v83, v12
    v_mfma_f32_16x16x32_bf16 v[228:231], v[72:75], v[36:39], 0
    ds_read_b64_tr_b16 v[70:71], v93 offset:41216
    v_fma_f32 v15, v15, s28, -v87
    v_mfma_f32_16x16x32_bf16 v[232:235], v[72:75], v[40:43], 0
    v_exp_f32 v15, v15
    v_mfma_f32_16x16x32_bf16 v[236:239], v[72:75], v[44:47], 0
    s_waitcnt lgkmcnt(4)
    v_add_f32 v83, v83, v13
    v_add_f32 v83, v83, v14
    v_mfma_f32_16x16x32_bf16 v[240:243], v[76:79], v[32:35], 0
    ds_read_b64_tr_b16 v[72:73], v94 offset:33024
    v_add_f32 v83, v83, v15
    v_mfma_f32_16x16x32_bf16 v[244:247], v[76:79], v[36:39], 0
    ds_read_b64_tr_b16 v[74:75], v94 offset:41216
    v_fma_f32 v16, v16, s28, -v84
    v_mfma_f32_16x16x32_bf16 v[248:251], v[76:79], v[40:43], 0
    buffer_load_dwordx4 v102, s[12:15], s32 offen offset:2048 lds
    v_mfma_f32_16x16x32_bf16 v[252:255], v[76:79], v[44:47], 0
    s_waitcnt lgkmcnt(4)
    v_exp_f32 v16, v16
    v_mfma_f32_16x16x32_bf16 a[128:131], v[64:67], v[32:35], 0
    ds_read_b64_tr_b16 v[76:77], v95 offset:33024
    v_fma_f32 v18, v18, s28, -v84
    v_mfma_f32_16x16x32_bf16 a[132:135], v[64:67], v[36:39], 0
    ds_read_b64_tr_b16 v[78:79], v95 offset:41216
    v_fma_f32 v17, v17, s28, -v84
    v_mfma_f32_16x16x32_bf16 a[136:139], v[64:67], v[40:43], 0
    v_exp_f32 v17, v17
    v_mfma_f32_16x16x32_bf16 a[140:143], v[64:67], v[44:47], 0
    s_waitcnt lgkmcnt(4)
    v_exp_f32 v18, v18
    v_mfma_f32_16x16x32_bf16 a[144:147], v[68:71], v[32:35], 0
    ds_read_b64_tr_b16 v[64:65], v96 offset:33024
    v_add_f32 v80, v80, v16
    v_mfma_f32_16x16x32_bf16 a[148:151], v[68:71], v[36:39], 0
    ds_read_b64_tr_b16 v[66:67], v96 offset:41216
    v_fma_f32 v19, v19, s28, -v84
    v_mfma_f32_16x16x32_bf16 a[152:155], v[68:71], v[40:43], 0
    v_add_f32 v80, v80, v18
    v_mfma_f32_16x16x32_bf16 a[156:159], v[68:71], v[44:47], 0
    s_waitcnt lgkmcnt(4)
    v_exp_f32 v19, v19
    v_mfma_f32_16x16x32_bf16 a[160:163], v[72:75], v[32:35], 0
    ds_read_b64_tr_b16 v[68:69], v97 offset:33024
    v_add_f32 v80, v80, v17
    v_mfma_f32_16x16x32_bf16 a[164:167], v[72:75], v[36:39], 0
    ds_read_b64_tr_b16 v[70:71], v97 offset:41216
    v_fma_f32 v20, v20, s28, -v85
    v_mfma_f32_16x16x32_bf16 a[168:171], v[72:75], v[40:43], 0
    buffer_load_dwordx4 v103, s[12:15], s32 offen offset:3072 lds
    v_mfma_f32_16x16x32_bf16 a[172:175], v[72:75], v[44:47], 0
    s_waitcnt lgkmcnt(4)
    v_exp_f32 v20, v20
    v_mfma_f32_16x16x32_bf16 a[176:179], v[76:79], v[32:35], 0
    s_add_u32 s32, s32, 16384
    ds_read_b64_tr_b16 v[72:73], v98 offset:33024
    v_add_f32 v80, v80, v19
    v_mfma_f32_16x16x32_bf16 a[180:183], v[76:79], v[36:39], 0
    ds_read_b64_tr_b16 v[74:75], v98 offset:41216
    v_fma_f32 v21, v21, s28, -v85
    v_mfma_f32_16x16x32_bf16 a[184:187], v[76:79], v[40:43], 0
    v_exp_f32 v21, v21
    v_mfma_f32_16x16x32_bf16 a[188:191], v[76:79], v[44:47], 0
    s_waitcnt lgkmcnt(4)
    v_add_f32 v81, v81, v20
    v_add_f32 v81, v81, v21
    v_mfma_f32_16x16x32_bf16 a[192:195], v[64:67], v[32:35], 0
    ds_read_b64_tr_b16 v[76:77], v99 offset:33024
    v_fma_f32 v23, v23, s28, -v85
    v_mfma_f32_16x16x32_bf16 a[196:199], v[64:67], v[36:39], 0
    ds_read_b64_tr_b16 v[78:79], v99 offset:41216
    v_fma_f32 v22, v22, s28, -v85
    v_mfma_f32_16x16x32_bf16 a[200:203], v[64:67], v[40:43], 0
    v_exp_f32 v22, v22
    v_mfma_f32_16x16x32_bf16 a[204:207], v[64:67], v[44:47], 0
    s_waitcnt lgkmcnt(4)
    v_mfma_f32_16x16x32_bf16 a[208:211], v[68:71], v[32:35], 0
    v_exp_f32 v23, v23
    v_mfma_f32_16x16x32_bf16 a[212:215], v[68:71], v[36:39], 0
    v_mfma_f32_16x16x32_bf16 a[216:219], v[68:71], v[40:43], 0
    v_mfma_f32_16x16x32_bf16 a[220:223], v[68:71], v[44:47], 0
    s_waitcnt vmcnt(8) lgkmcnt(0)
    s_barrier
    v_mfma_f32_16x16x32_bf16 a[224:227], v[72:75], v[32:35], 0
    ds_read_b128 v[64:67], v88 offset:0
    v_add_f32 v81, v81, v22
    v_mfma_f32_16x16x32_bf16 a[228:231], v[72:75], v[36:39], 0
    ds_read_b128 v[68:71], v89 offset:0
    v_add_f32 v81, v81, v23
    v_mfma_f32_16x16x32_bf16 a[232:235], v[72:75], v[40:43], 0
    v_mfma_f32_16x16x32_bf16 a[236:239], v[72:75], v[44:47], 0
    s_waitcnt lgkmcnt(2)
    v_mfma_f32_16x16x32_bf16 a[240:243], v[76:79], v[32:35], 0
    v_cvt_pk_bf16_f32 v34, v16, v17
    v_cvt_pk_bf16_f32 v35, v18, v19
    v_mfma_f32_16x16x32_bf16 a[244:247], v[76:79], v[36:39], 0
    v_cvt_pk_bf16_f32 v32, v0, v1
    v_cvt_pk_bf16_f32 v33, v2, v3
    v_mfma_f32_16x16x32_bf16 a[248:251], v[76:79], v[40:43], 0
    v_cvt_pk_bf16_f32 v36, v4, v5
    v_cvt_pk_bf16_f32 v37, v6, v7
    v_mfma_f32_16x16x32_bf16 a[252:255], v[76:79], v[44:47], 0
    s_waitcnt lgkmcnt(0)
    s_mov_b32 s46, 7
    .p2align 6
L_loop1:
    v_mfma_f32_16x16x32_bf16 v[0:3], v[64:67], a[0:3], 0
    ds_read_b128 v[72:75], v90 offset:0
    v_cvt_pk_bf16_f32 v38, v20, v21
    v_mfma_f32_16x16x32_bf16 v[0:3], v[68:71], a[4:7], v[0:3]
    v_cvt_pk_bf16_f32 v40, v8, v9
    v_cvt_pk_bf16_f32 v41, v10, v11
    v_mfma_f32_16x16x32_bf16 v[4:7], v[64:67], a[32:35], 0
    ds_read_b128 v[76:79], v91 offset:0
    v_cvt_pk_bf16_f32 v39, v22, v23
    v_mfma_f32_16x16x32_bf16 v[4:7], v[68:71], a[36:39], v[4:7]
    v_cvt_pk_bf16_f32 v44, v12, v13
    v_cvt_pk_bf16_f32 v45, v14, v15
    v_mfma_f32_16x16x32_bf16 v[8:11], v[64:67], a[64:67], 0
    s_mov_b32 m0, s36
    v_mfma_f32_16x16x32_bf16 v[8:11], v[68:71], a[68:71], v[8:11]
    v_fma_f32 v24, v24, s28, -v86
    v_mfma_f32_16x16x32_bf16 v[12:15], v[64:67], a[96:99], 0
    buffer_load_dwordx4 v104, s[16:19], s33 offen lds
    v_mfma_f32_16x16x32_bf16 v[12:15], v[68:71], a[100:103], v[12:15]
    s_waitcnt lgkmcnt(0)
    v_exp_f32 v24, v24
    v_mfma_f32_16x16x32_bf16 v[0:3], v[72:75], a[8:11], v[0:3]
    ds_read_b128 v[64:67], v88 offset:256
    v_fma_f32 v25, v25, s28, -v86
    v_mfma_f32_16x16x32_bf16 v[0:3], v[76:79], a[12:15], v[0:3]
    v_exp_f32 v25, v25
    v_mfma_f32_16x16x32_bf16 v[4:7], v[72:75], a[40:43], v[4:7]
    ds_read_b128 v[68:71], v89 offset:256
    v_cvt_pk_bf16_f32 v42, v24, v25
    v_mfma_f32_16x16x32_bf16 v[4:7], v[76:79], a[44:47], v[4:7]
    v_fma_f32 v26, v26, s28, -v86
    v_fma_f32 v27, v27, s28, -v86
    v_mfma_f32_16x16x32_bf16 v[8:11], v[72:75], a[72:75], v[8:11]
    v_exp_f32 v26, v26
    v_mfma_f32_16x16x32_bf16 v[8:11], v[76:79], a[76:79], v[8:11]
    v_add_f32 v82, v82, v24
    v_add_f32 v82, v82, v25
    v_mfma_f32_16x16x32_bf16 v[12:15], v[72:75], a[104:107], v[12:15]
    buffer_load_dwordx4 v105, s[16:19], s33 offen offset:1024 lds
    v_mfma_f32_16x16x32_bf16 v[12:15], v[76:79], a[108:111], v[12:15]
    s_waitcnt lgkmcnt(0)
    v_exp_f32 v27, v27
    v_mfma_f32_16x16x32_bf16 v[0:3], v[64:67], a[16:19], v[0:3]
    ds_read_b128 v[72:75], v90 offset:256
    v_cvt_pk_bf16_f32 v43, v26, v27
    v_mfma_f32_16x16x32_bf16 v[0:3], v[68:71], a[20:23], v[0:3]
    v_add_f32 v82, v82, v26
    v_add_f32 v82, v82, v27
    v_mfma_f32_16x16x32_bf16 v[4:7], v[64:67], a[48:51], v[4:7]
    ds_read_b128 v[76:79], v91 offset:256
    v_fma_f32 v28, v28, s28, -v87
    v_mfma_f32_16x16x32_bf16 v[4:7], v[68:71], a[52:55], v[4:7]
    v_exp_f32 v28, v28
    v_mfma_f32_16x16x32_bf16 v[8:11], v[64:67], a[80:83], v[8:11]
    v_fma_f32 v29, v29, s28, -v87
    v_add_f32 v83, v83, v28
    v_mfma_f32_16x16x32_bf16 v[8:11], v[68:71], a[84:87], v[8:11]
    v_exp_f32 v29, v29
    v_mfma_f32_16x16x32_bf16 v[12:15], v[64:67], a[112:115], v[12:15]
    buffer_load_dwordx4 v106, s[16:19], s33 offen offset:2048 lds
    v_mfma_f32_16x16x32_bf16 v[12:15], v[68:71], a[116:119], v[12:15]
    s_waitcnt lgkmcnt(0)
    v_add_f32 v83, v83, v29
    v_cvt_pk_bf16_f32 v46, v28, v29
    v_mfma_f32_16x16x32_bf16 v[0:3], v[72:75], a[24:27], v[0:3]
    ds_read_b128 v[64:67], v88 offset:8192
    v_fma_f32 v30, v30, s28, -v87
    v_mfma_f32_16x16x32_bf16 v[0:3], v[76:79], a[28:31], v[0:3]
    v_exp_f32 v30, v30
    v_mfma_f32_16x16x32_bf16 v[4:7], v[72:75], a[56:59], v[4:7]
    ds_read_b128 v[68:71], v89 offset:8192
    v_fma_f32 v31, v31, s28, -v87
    v_mfma_f32_16x16x32_bf16 v[4:7], v[76:79], a[60:63], v[4:7]
    v_exp_f32 v31, v31
    v_mfma_f32_16x16x32_bf16 v[8:11], v[72:75], a[88:91], v[8:11]
    v_add_f32 v83, v83, v30
    v_cvt_pk_bf16_f32 v47, v30, v31
    v_mfma_f32_16x16x32_bf16 v[8:11], v[76:79], a[92:95], v[8:11]
    v_mfma_f32_16x16x32_bf16 v[12:15], v[72:75], a[120:123], v[12:15]
    buffer_load_dwordx4 v107, s[16:19], s33 offen offset:3072 lds
    v_mfma_f32_16x16x32_bf16 v[12:15], v[76:79], a[124:127], v[12:15]
    s_waitcnt lgkmcnt(0)
    v_mfma_f32_16x16x32_bf16 v[16:19], v[64:67], a[0:3], 0
    s_add_u32 s33, s33, 16384
    ds_read_b128 v[72:75], v90 offset:8192
    v_add_f32 v83, v83, v31
    v_mfma_f32_16x16x32_bf16 v[16:19], v[68:71], a[4:7], v[16:19]
    s_cmp_gt_u32 s46, 2
    v_mfma_f32_16x16x32_bf16 v[20:23], v[64:67], a[32:35], 0
    s_cselect_b32 s44, 4096, 0
    ds_read_b128 v[76:79], v91 offset:8192
    v_fma_f32 v0, v0, s28, -v84
    v_mfma_f32_16x16x32_bf16 v[20:23], v[68:71], a[36:39], v[20:23]
    s_cselect_b32 s59, s58, 0
    v_mfma_f32_16x16x32_bf16 v[24:27], v[64:67], a[64:67], 0
    ds_read_b128 v[48:51], v114 offset:0
    v_mfma_f32_16x16x32_bf16 v[24:27], v[68:71], a[68:71], v[24:27]
    s_cmp_eq_u32 s46, 1
    v_mfma_f32_16x16x32_bf16 v[28:31], v[64:67], a[96:99], 0
    s_cselect_b32 s34, 0x3f000, s34
    v_exp_f32 v0, v0
    v_mfma_f32_16x16x32_bf16 v[28:31], v[68:71], a[100:103], v[28:31]
    s_waitcnt lgkmcnt(1)
    v_add_f32 v80, v80, v0
    v_mfma_f32_16x16x32_bf16 v[16:19], v[72:75], a[8:11], v[16:19]
    ds_read_b128 v[64:67], v88 offset:8448
    v_fma_f32 v1, v1, s28, -v84
    v_mfma_f32_16x16x32_bf16 v[16:19], v[76:79], a[12:15], v[16:19]
    s_cselect_b32 s35, 0x3f000, s35
    v_exp_f32 v1, v1
    v_mfma_f32_16x16x32_bf16 v[20:23], v[72:75], a[40:43], v[20:23]
    s_cselect_b32 s43, 0x4000000, s43
    ds_read_b128 v[68:71], v89 offset:8448
    v_fma_f32 v2, v2, s28, -v84
    v_mfma_f32_16x16x32_bf16 v[20:23], v[76:79], a[44:47], v[20:23]
    v_mfma_f32_16x16x32_bf16 v[24:27], v[72:75], a[72:75], v[24:27]
    ds_read_b128 v[52:55], v114 offset:1024
    v_mfma_f32_16x16x32_bf16 v[24:27], v[76:79], a[76:79], v[24:27]
    v_exp_f32 v2, v2
    v_mfma_f32_16x16x32_bf16 v[28:31], v[72:75], a[104:107], v[28:31]
    v_add_f32 v80, v80, v1
    v_mfma_f32_16x16x32_bf16 v[28:31], v[76:79], a[108:111], v[28:31]
    s_waitcnt lgkmcnt(1)
    v_add_f32 v80, v80, v2
    v_mfma_f32_16x16x32_bf16 v[16:19], v[64:67], a[16:19], v[16:19]
    ds_read_b128 v[72:75], v90 offset:8448
    v_fma_f32 v3, v3, s28, -v84
    v_mfma_f32_16x16x32_bf16 v[16:19], v[68:71], a[20:23], v[16:19]
    v_exp_f32 v3, v3
    v_mfma_f32_16x16x32_bf16 v[20:23], v[64:67], a[48:51], v[20:23]
    ds_read_b128 v[76:79], v91 offset:8448
    v_fma_f32 v4, v4, s28, -v85
    v_mfma_f32_16x16x32_bf16 v[20:23], v[68:71], a[52:55], v[20:23]
    s_add_u32 s50, s43, 0
    v_add_f32 v80, v80, v3
    v_mfma_f32_16x16x32_bf16 v[24:27], v[64:67], a[80:83], v[24:27]
    buffer_store_dwordx4 v[48:51], v117, s[20:23], s50 offen nt
    v_mfma_f32_16x16x32_bf16 v[24:27], v[68:71], a[84:87], v[24:27]
    v_exp_f32 v4, v4
    v_mfma_f32_16x16x32_bf16 v[28:31], v[64:67], a[112:115], v[28:31]
    v_mfma_f32_16x16x32_bf16 v[28:31], v[68:71], a[116:119], v[28:31]
    s_waitcnt vmcnt(9) lgkmcnt(0)
    s_barrier
    v_mfma_f32_16x16x32_bf16 v[16:19], v[72:75], a[24:27], v[16:19]
    ds_read_b64_tr_b16 v[64:65], v92 offset:49152
    v_add_f32 v81, v81, v4
    v_mfma_f32_16x16x32_bf16 v[16:19], v[76:79], a[28:31], v[16:19]
    ds_read_b64_tr_b16 v[66:67], v92 offset:57344
    v_fma_f32 v7, v7, s28, -v85
    v_mfma_f32_16x16x32_bf16 v[20:23], v[72:75], a[56:59], v[20:23]
    ds_read_b64_tr_b16 v[68:69], v93 offset:49152
    v_fma_f32 v6, v6, s28, -v85
    v_mfma_f32_16x16x32_bf16 v[20:23], v[76:79], a[60:63], v[20:23]
    ds_read_b64_tr_b16 v[70:71], v93 offset:57344
    v_fma_f32 v5, v5, s28, -v85
    v_mfma_f32_16x16x32_bf16 v[24:27], v[72:75], a[88:91], v[24:27]
    v_exp_f32 v5, v5
    v_mfma_f32_16x16x32_bf16 v[24:27], v[76:79], a[92:95], v[24:27]
    s_add_u32 s51, s43, 4096
    v_exp_f32 v6, v6
    v_mfma_f32_16x16x32_bf16 v[28:31], v[72:75], a[120:123], v[28:31]
    buffer_store_dwordx4 v[52:55], v117, s[20:23], s51 offen nt
    v_mfma_f32_16x16x32_bf16 v[28:31], v[76:79], a[124:127], v[28:31]
    s_waitcnt lgkmcnt(2)
    v_exp_f32 v7, v7
    v_mfma_f32_16x16x32_bf16 v[128:131], v[64:67], v[32:35], v[128:131]
    ds_read_b64_tr_b16 v[72:73], v94 offset:49152
    v_add_f32 v81, v81, v5
    v_mfma_f32_16x16x32_bf16 v[132:135], v[64:67], v[36:39], v[132:135]
    ds_read_b64_tr_b16 v[74:75], v94 offset:57344
    v_add_f32 v81, v81, v6
    v_mfma_f32_16x16x32_bf16 v[136:139], v[64:67], v[40:43], v[136:139]
    ds_read_b64_tr_b16 v[76:77], v95 offset:49152
    v_add_f32 v81, v81, v7
    v_mfma_f32_16x16x32_bf16 v[140:143], v[64:67], v[44:47], v[140:143]
    s_waitcnt lgkmcnt(3)
    ds_read_b64_tr_b16 v[78:79], v95 offset:57344
    v_mfma_f32_16x16x32_bf16 v[144:147], v[68:71], v[32:35], v[144:147]
    s_mov_b32 m0, s34
    ds_read_b64_tr_b16 v[64:65], v96 offset:49152
    v_mfma_f32_16x16x32_bf16 v[148:151], v[68:71], v[36:39], v[148:151]
    ds_read_b64_tr_b16 v[66:67], v96 offset:57344
    v_fma_f32 v8, v8, s28, -v86
    v_mfma_f32_16x16x32_bf16 v[152:155], v[68:71], v[40:43], v[152:155]
    buffer_load_dwordx4 v100, s[12:15], s32 offen lds
    v_mfma_f32_16x16x32_bf16 v[156:159], v[68:71], v[44:47], v[156:159]
    s_waitcnt lgkmcnt(4)
    v_exp_f32 v8, v8
    v_mfma_f32_16x16x32_bf16 v[160:163], v[72:75], v[32:35], v[160:163]
    ds_read_b64_tr_b16 v[68:69], v97 offset:49152
    v_fma_f32 v10, v10, s28, -v86
    v_mfma_f32_16x16x32_bf16 v[164:167], v[72:75], v[36:39], v[164:167]
    ds_read_b64_tr_b16 v[70:71], v97 offset:57344
    v_fma_f32 v9, v9, s28, -v86
    v_mfma_f32_16x16x32_bf16 v[168:171], v[72:75], v[40:43], v[168:171]
    v_exp_f32 v9, v9
    v_mfma_f32_16x16x32_bf16 v[172:175], v[72:75], v[44:47], v[172:175]
    s_waitcnt lgkmcnt(4)
    v_exp_f32 v10, v10
    v_mfma_f32_16x16x32_bf16 v[176:179], v[76:79], v[32:35], v[176:179]
    ds_read_b64_tr_b16 v[72:73], v98 offset:49152
    v_fma_f32 v12, v12, s28, -v87
    v_mfma_f32_16x16x32_bf16 v[180:183], v[76:79], v[36:39], v[180:183]
    ds_read_b64_tr_b16 v[74:75], v98 offset:57344
    v_fma_f32 v11, v11, s28, -v86
    v_mfma_f32_16x16x32_bf16 v[184:187], v[76:79], v[40:43], v[184:187]
    v_exp_f32 v11, v11
    v_mfma_f32_16x16x32_bf16 v[188:191], v[76:79], v[44:47], v[188:191]
    s_waitcnt lgkmcnt(4)
    v_exp_f32 v12, v12
    v_mfma_f32_16x16x32_bf16 v[192:195], v[64:67], v[32:35], v[192:195]
    ds_read_b64_tr_b16 v[76:77], v99 offset:49152
    v_add_f32 v82, v82, v8
    v_mfma_f32_16x16x32_bf16 v[196:199], v[64:67], v[36:39], v[196:199]
    ds_read_b64_tr_b16 v[78:79], v99 offset:57344
    v_fma_f32 v13, v13, s28, -v87
    v_mfma_f32_16x16x32_bf16 v[200:203], v[64:67], v[40:43], v[200:203]
    buffer_load_dwordx4 v101, s[12:15], s32 offen offset:1024 lds
    v_mfma_f32_16x16x32_bf16 v[204:207], v[64:67], v[44:47], v[204:207]
    s_waitcnt lgkmcnt(4)
    v_exp_f32 v13, v13
    v_mfma_f32_16x16x32_bf16 v[208:211], v[68:71], v[32:35], v[208:211]
    ds_read_b64_tr_b16 v[64:65], v92 offset:49408
    v_add_f32 v82, v82, v9
    v_mfma_f32_16x16x32_bf16 v[212:215], v[68:71], v[36:39], v[212:215]
    ds_read_b64_tr_b16 v[66:67], v92 offset:57600
    v_fma_f32 v14, v14, s28, -v87
    v_mfma_f32_16x16x32_bf16 v[216:219], v[68:71], v[40:43], v[216:219]
    v_exp_f32 v14, v14
    v_mfma_f32_16x16x32_bf16 v[220:223], v[68:71], v[44:47], v[220:223]
    s_waitcnt lgkmcnt(4)
    v_add_f32 v82, v82, v10
    v_add_f32 v82, v82, v11
    v_mfma_f32_16x16x32_bf16 v[224:227], v[72:75], v[32:35], v[224:227]
    ds_read_b64_tr_b16 v[68:69], v93 offset:49408
    v_add_f32 v83, v83, v12
    v_mfma_f32_16x16x32_bf16 v[228:231], v[72:75], v[36:39], v[228:231]
    ds_read_b64_tr_b16 v[70:71], v93 offset:57600
    v_fma_f32 v15, v15, s28, -v87
    v_mfma_f32_16x16x32_bf16 v[232:235], v[72:75], v[40:43], v[232:235]
    v_exp_f32 v15, v15
    v_mfma_f32_16x16x32_bf16 v[236:239], v[72:75], v[44:47], v[236:239]
    s_waitcnt lgkmcnt(4)
    v_add_f32 v83, v83, v13
    v_add_f32 v83, v83, v14
    v_mfma_f32_16x16x32_bf16 v[240:243], v[76:79], v[32:35], v[240:243]
    ds_read_b64_tr_b16 v[72:73], v94 offset:49408
    v_add_f32 v83, v83, v15
    v_mfma_f32_16x16x32_bf16 v[244:247], v[76:79], v[36:39], v[244:247]
    ds_read_b64_tr_b16 v[74:75], v94 offset:57600
    v_fma_f32 v16, v16, s28, -v84
    v_mfma_f32_16x16x32_bf16 v[248:251], v[76:79], v[40:43], v[248:251]
    buffer_load_dwordx4 v102, s[12:15], s32 offen offset:2048 lds
    v_mfma_f32_16x16x32_bf16 v[252:255], v[76:79], v[44:47], v[252:255]
    s_waitcnt lgkmcnt(4)
    v_exp_f32 v16, v16
    v_mfma_f32_16x16x32_bf16 a[128:131], v[64:67], v[32:35], a[128:131]
    ds_read_b64_tr_b16 v[76:77], v95 offset:49408
    v_fma_f32 v18, v18, s28, -v84
    v_mfma_f32_16x16x32_bf16 a[132:135], v[64:67], v[36:39], a[132:135]
    ds_read_b64_tr_b16 v[78:79], v95 offset:57600
    v_fma_f32 v17, v17, s28, -v84
    v_mfma_f32_16x16x32_bf16 a[136:139], v[64:67], v[40:43], a[136:139]
    v_exp_f32 v17, v17
    v_mfma_f32_16x16x32_bf16 a[140:143], v[64:67], v[44:47], a[140:143]
    s_waitcnt lgkmcnt(4)
    v_exp_f32 v18, v18
    v_mfma_f32_16x16x32_bf16 a[144:147], v[68:71], v[32:35], a[144:147]
    ds_read_b64_tr_b16 v[64:65], v96 offset:49408
    v_add_f32 v80, v80, v16
    v_mfma_f32_16x16x32_bf16 a[148:151], v[68:71], v[36:39], a[148:151]
    ds_read_b64_tr_b16 v[66:67], v96 offset:57600
    v_fma_f32 v19, v19, s28, -v84
    v_mfma_f32_16x16x32_bf16 a[152:155], v[68:71], v[40:43], a[152:155]
    v_add_f32 v80, v80, v18
    v_mfma_f32_16x16x32_bf16 a[156:159], v[68:71], v[44:47], a[156:159]
    s_waitcnt lgkmcnt(4)
    v_exp_f32 v19, v19
    v_mfma_f32_16x16x32_bf16 a[160:163], v[72:75], v[32:35], a[160:163]
    ds_read_b64_tr_b16 v[68:69], v97 offset:49408
    v_add_f32 v80, v80, v17
    v_mfma_f32_16x16x32_bf16 a[164:167], v[72:75], v[36:39], a[164:167]
    ds_read_b64_tr_b16 v[70:71], v97 offset:57600
    v_fma_f32 v20, v20, s28, -v85
    v_mfma_f32_16x16x32_bf16 a[168:171], v[72:75], v[40:43], a[168:171]
    buffer_load_dwordx4 v103, s[12:15], s32 offen offset:3072 lds
    v_mfma_f32_16x16x32_bf16 a[172:175], v[72:75], v[44:47], a[172:175]
    s_waitcnt lgkmcnt(4)
    v_exp_f32 v20, v20
    v_mfma_f32_16x16x32_bf16 a[176:179], v[76:79], v[32:35], a[176:179]
    s_add_u32 s32, s32, 16384
    ds_read_b64_tr_b16 v[72:73], v98 offset:49408
    v_add_f32 v80, v80, v19
    v_mfma_f32_16x16x32_bf16 a[180:183], v[76:79], v[36:39], a[180:183]
    ds_read_b64_tr_b16 v[74:75], v98 offset:57600
    v_fma_f32 v21, v21, s28, -v85
    v_mfma_f32_16x16x32_bf16 a[184:187], v[76:79], v[40:43], a[184:187]
    v_exp_f32 v21, v21
    v_mfma_f32_16x16x32_bf16 a[188:191], v[76:79], v[44:47], a[188:191]
    s_waitcnt lgkmcnt(4)
    v_add_f32 v81, v81, v20
    v_add_f32 v81, v81, v21
    v_mfma_f32_16x16x32_bf16 a[192:195], v[64:67], v[32:35], a[192:195]
    ds_read_b64_tr_b16 v[76:77], v99 offset:49408
    v_fma_f32 v23, v23, s28, -v85
    v_mfma_f32_16x16x32_bf16 a[196:199], v[64:67], v[36:39], a[196:199]
    ds_read_b64_tr_b16 v[78:79], v99 offset:57600
    v_fma_f32 v22, v22, s28, -v85
    v_mfma_f32_16x16x32_bf16 a[200:203], v[64:67], v[40:43], a[200:203]
    v_exp_f32 v22, v22
    v_mfma_f32_16x16x32_bf16 a[204:207], v[64:67], v[44:47], a[204:207]
    s_waitcnt lgkmcnt(4)
    v_mfma_f32_16x16x32_bf16 a[208:211], v[68:71], v[32:35], a[208:211]
    v_exp_f32 v23, v23
    v_mfma_f32_16x16x32_bf16 a[212:215], v[68:71], v[36:39], a[212:215]
    v_mfma_f32_16x16x32_bf16 a[216:219], v[68:71], v[40:43], a[216:219]
    v_mfma_f32_16x16x32_bf16 a[220:223], v[68:71], v[44:47], a[220:223]
    s_waitcnt vmcnt(10) lgkmcnt(0)
    s_barrier
    v_mfma_f32_16x16x32_bf16 a[224:227], v[72:75], v[32:35], a[224:227]
    ds_read_b128 v[64:67], v88 offset:16384
    v_add_f32 v81, v81, v22
    v_mfma_f32_16x16x32_bf16 a[228:231], v[72:75], v[36:39], a[228:231]
    ds_read_b128 v[68:71], v89 offset:16384
    v_add_f32 v81, v81, v23
    v_mfma_f32_16x16x32_bf16 a[232:235], v[72:75], v[40:43], a[232:235]
    v_mfma_f32_16x16x32_bf16 a[236:239], v[72:75], v[44:47], a[236:239]
    s_waitcnt lgkmcnt(2)
    v_mfma_f32_16x16x32_bf16 a[240:243], v[76:79], v[32:35], a[240:243]
    v_cvt_pk_bf16_f32 v34, v16, v17
    v_cvt_pk_bf16_f32 v35, v18, v19
    v_mfma_f32_16x16x32_bf16 a[244:247], v[76:79], v[36:39], a[244:247]
    v_cvt_pk_bf16_f32 v32, v0, v1
    v_cvt_pk_bf16_f32 v33, v2, v3
    v_mfma_f32_16x16x32_bf16 a[248:251], v[76:79], v[40:43], a[248:251]
    v_cvt_pk_bf16_f32 v36, v4, v5
    v_cvt_pk_bf16_f32 v37, v6, v7
    v_mfma_f32_16x16x32_bf16 a[252:255], v[76:79], v[44:47], a[252:255]
    s_waitcnt lgkmcnt(0)
    v_mfma_f32_16x16x32_bf16 v[0:3], v[64:67], a[0:3], 0
    ds_read_b128 v[72:75], v90 offset:16384
    v_cvt_pk_bf16_f32 v38, v20, v21
    v_mfma_f32_16x16x32_bf16 v[0:3], v[68:71], a[4:7], v[0:3]
    v_cvt_pk_bf16_f32 v40, v8, v9
    v_cvt_pk_bf16_f32 v41, v10, v11
    v_mfma_f32_16x16x32_bf16 v[4:7], v[64:67], a[32:35], 0
    ds_read_b128 v[76:79], v91 offset:16384
    v_cvt_pk_bf16_f32 v39, v22, v23
    v_mfma_f32_16x16x32_bf16 v[4:7], v[68:71], a[36:39], v[4:7]
    v_cvt_pk_bf16_f32 v44, v12, v13
    v_cvt_pk_bf16_f32 v45, v14, v15
    v_mfma_f32_16x16x32_bf16 v[8:11], v[64:67], a[64:67], 0
    s_mov_b32 m0, s37
    v_mfma_f32_16x16x32_bf16 v[8:11], v[68:71], a[68:71], v[8:11]
    v_fma_f32 v24, v24, s28, -v86
    v_mfma_f32_16x16x32_bf16 v[12:15], v[64:67], a[96:99], 0
    buffer_load_dwordx4 v104, s[16:19], s33 offen lds
    v_mfma_f32_16x16x32_bf16 v[12:15], v[68:71], a[100:103], v[12:15]
    s_waitcnt lgkmcnt(0)
    v_exp_f32 v24, v24
    v_mfma_f32_16x16x32_bf16 v[0:3], v[72:75], a[8:11], v[0:3]
    ds_read_b128 v[64:67], v88 offset:16640
    v_fma_f32 v25, v25, s28, -v86
    v_mfma_f32_16x16x32_bf16 v[0:3], v[76:79], a[12:15], v[0:3]
    v_exp_f32 v25, v25
    v_mfma_f32_16x16x32_bf16 v[4:7], v[72:75], a[40:43], v[4:7]
    ds_read_b128 v[68:71], v89 offset:16640
    v_cvt_pk_bf16_f32 v42, v24, v25
    v_mfma_f32_16x16x32_bf16 v[4:7], v[76:79], a[44:47], v[4:7]
    v_fma_f32 v26, v26, s28, -v86
    v_fma_f32 v27, v27, s28, -v86
    v_mfma_f32_16x16x32_bf16 v[8:11], v[72:75], a[72:75], v[8:11]
    v_exp_f32 v26, v26
    v_mfma_f32_16x16x32_bf16 v[8:11], v[76:79], a[76:79], v[8:11]
    v_add_f32 v82, v82, v24
    v_add_f32 v82, v82, v25
    v_mfma_f32_16x16x32_bf16 v[12:15], v[72:75], a[104:107], v[12:15]
    buffer_load_dwordx4 v105, s[16:19], s33 offen offset:1024 lds
    v_mfma_f32_16x16x32_bf16 v[12:15], v[76:79], a[108:111], v[12:15]
    s_waitcnt lgkmcnt(0)
    v_exp_f32 v27, v27
    v_mfma_f32_16x16x32_bf16 v[0:3], v[64:67], a[16:19], v[0:3]
    ds_read_b128 v[72:75], v90 offset:16640
    v_cvt_pk_bf16_f32 v43, v26, v27
    v_mfma_f32_16x16x32_bf16 v[0:3], v[68:71], a[20:23], v[0:3]
    v_add_f32 v82, v82, v26
    v_add_f32 v82, v82, v27
    v_mfma_f32_16x16x32_bf16 v[4:7], v[64:67], a[48:51], v[4:7]
    ds_read_b128 v[76:79], v91 offset:16640
    v_fma_f32 v28, v28, s28, -v87
    v_mfma_f32_16x16x32_bf16 v[4:7], v[68:71], a[52:55], v[4:7]
    v_exp_f32 v28, v28
    v_mfma_f32_16x16x32_bf16 v[8:11], v[64:67], a[80:83], v[8:11]
    v_fma_f32 v29, v29, s28, -v87
    v_add_f32 v83, v83, v28
    v_mfma_f32_16x16x32_bf16 v[8:11], v[68:71], a[84:87], v[8:11]
    v_exp_f32 v29, v29
    v_mfma_f32_16x16x32_bf16 v[12:15], v[64:67], a[112:115], v[12:15]
    buffer_load_dwordx4 v106, s[16:19], s33 offen offset:2048 lds
    v_mfma_f32_16x16x32_bf16 v[12:15], v[68:71], a[116:119], v[12:15]
    s_waitcnt lgkmcnt(0)
    v_add_f32 v83, v83, v29
    v_cvt_pk_bf16_f32 v46, v28, v29
    v_mfma_f32_16x16x32_bf16 v[0:3], v[72:75], a[24:27], v[0:3]
    ds_read_b128 v[64:67], v88 offset:24576
    v_fma_f32 v30, v30, s28, -v87
    v_mfma_f32_16x16x32_bf16 v[0:3], v[76:79], a[28:31], v[0:3]
    v_exp_f32 v30, v30
    v_mfma_f32_16x16x32_bf16 v[4:7], v[72:75], a[56:59], v[4:7]
    ds_read_b128 v[68:71], v89 offset:24576
    v_fma_f32 v31, v31, s28, -v87
    v_mfma_f32_16x16x32_bf16 v[4:7], v[76:79], a[60:63], v[4:7]
    v_exp_f32 v31, v31
    v_mfma_f32_16x16x32_bf16 v[8:11], v[72:75], a[88:91], v[8:11]
    v_add_f32 v83, v83, v30
    v_cvt_pk_bf16_f32 v47, v30, v31
    v_mfma_f32_16x16x32_bf16 v[8:11], v[76:79], a[92:95], v[8:11]
    v_mfma_f32_16x16x32_bf16 v[12:15], v[72:75], a[120:123], v[12:15]
    buffer_load_dwordx4 v107, s[16:19], s33 offen offset:3072 lds
    v_mfma_f32_16x16x32_bf16 v[12:15], v[76:79], a[124:127], v[12:15]
    s_waitcnt lgkmcnt(0)
    v_mfma_f32_16x16x32_bf16 v[16:19], v[64:67], a[0:3], 0
    s_add_u32 s33, s33, 16384
    ds_read_b128 v[72:75], v90 offset:24576
    v_add_f32 v83, v83, v31
    v_mfma_f32_16x16x32_bf16 v[16:19], v[68:71], a[4:7], v[16:19]
    v_mfma_f32_16x16x32_bf16 v[20:23], v[64:67], a[32:35], 0
    ds_read_b128 v[76:79], v91 offset:24576
    v_fma_f32 v0, v0, s28, -v84
    v_mfma_f32_16x16x32_bf16 v[20:23], v[68:71], a[36:39], v[20:23]
    v_mfma_f32_16x16x32_bf16 v[24:27], v[64:67], a[64:67], 0
    ds_read_b128 v[48:51], v114 offset:2048
    v_mfma_f32_16x16x32_bf16 v[24:27], v[68:71], a[68:71], v[24:27]
    v_mfma_f32_16x16x32_bf16 v[28:31], v[64:67], a[96:99], 0
    v_exp_f32 v0, v0
    v_mfma_f32_16x16x32_bf16 v[28:31], v[68:71], a[100:103], v[28:31]
    s_waitcnt lgkmcnt(1)
    v_add_f32 v80, v80, v0
    v_mfma_f32_16x16x32_bf16 v[16:19], v[72:75], a[8:11], v[16:19]
    ds_read_b128 v[64:67], v88 offset:24832
    v_fma_f32 v1, v1, s28, -v84
    v_mfma_f32_16x16x32_bf16 v[16:19], v[76:79], a[12:15], v[16:19]
    v_exp_f32 v1, v1
    v_mfma_f32_16x16x32_bf16 v[20:23], v[72:75], a[40:43], v[20:23]
    ds_read_b128 v[68:71], v89 offset:24832
    v_fma_f32 v2, v2, s28, -v84
    v_mfma_f32_16x16x32_bf16 v[20:23], v[76:79], a[44:47], v[20:23]
    v_mfma_f32_16x16x32_bf16 v[24:27], v[72:75], a[72:75], v[24:27]
    ds_read_b128 v[52:55], v114 offset:3072
    v_mfma_f32_16x16x32_bf16 v[24:27], v[76:79], a[76:79], v[24:27]
    v_exp_f32 v2, v2
    v_mfma_f32_16x16x32_bf16 v[28:31], v[72:75], a[104:107], v[28:31]
    v_add_u32 v114, s44, v114
    v_add_f32 v80, v80, v1
    v_mfma_f32_16x16x32_bf16 v[28:31], v[76:79], a[108:111], v[28:31]
    s_waitcnt lgkmcnt(1)
    v_add_f32 v80, v80, v2
    v_mfma_f32_16x16x32_bf16 v[16:19], v[64:67], a[16:19], v[16:19]
    ds_read_b128 v[72:75], v90 offset:24832
    v_fma_f32 v3, v3, s28, -v84
    v_mfma_f32_16x16x32_bf16 v[16:19], v[68:71], a[20:23], v[16:19]
    v_exp_f32 v3, v3
    v_mfma_f32_16x16x32_bf16 v[20:23], v[64:67], a[48:51], v[20:23]
    ds_read_b128 v[76:79], v91 offset:24832
    v_fma_f32 v4, v4, s28, -v85
    v_mfma_f32_16x16x32_bf16 v[20:23], v[68:71], a[52:55], v[20:23]
    s_add_u32 s50, s43, 8192
    v_add_f32 v80, v80, v3
    v_mfma_f32_16x16x32_bf16 v[24:27], v[64:67], a[80:83], v[24:27]
    buffer_store_dwordx4 v[48:51], v117, s[20:23], s50 offen nt
    v_mfma_f32_16x16x32_bf16 v[24:27], v[68:71], a[84:87], v[24:27]
    v_exp_f32 v4, v4
    v_mfma_f32_16x16x32_bf16 v[28:31], v[64:67], a[112:115], v[28:31]
    v_mfma_f32_16x16x32_bf16 v[28:31], v[68:71], a[116:119], v[28:31]
    s_waitcnt vmcnt(11) lgkmcnt(0)
    s_barrier
    v_mfma_f32_16x16x32_bf16 v[16:19], v[72:75], a[24:27], v[16:19]
    ds_read_b64_tr_b16 v[64:65], v92 offset:32768
    v_add_f32 v81, v81, v4
    v_mfma_f32_16x16x32_bf16 v[16:19], v[76:79], a[28:31], v[16:19]
    ds_read_b64_tr_b16 v[66:67], v92 offset:40960
    v_fma_f32 v7, v7, s28, -v85
    v_mfma_f32_16x16x32_bf16 v[20:23], v[72:75], a[56:59], v[20:23]
    ds_read_b64_tr_b16 v[68:69], v93 offset:32768
    v_fma_f32 v6, v6, s28, -v85
    v_mfma_f32_16x16x32_bf16 v[20:23], v[76:79], a[60:63], v[20:23]
    ds_read_b64_tr_b16 v[70:71], v93 offset:40960
    v_fma_f32 v5, v5, s28, -v85
    v_mfma_f32_16x16x32_bf16 v[24:27], v[72:75], a[88:91], v[24:27]
    v_exp_f32 v5, v5
    v_mfma_f32_16x16x32_bf16 v[24:27], v[76:79], a[92:95], v[24:27]
    s_add_u32 s51, s43, 12288
    v_exp_f32 v6, v6
    v_mfma_f32_16x16x32_bf16 v[28:31], v[72:75], a[120:123], v[28:31]
    buffer_store_dwordx4 v[52:55], v117, s[20:23], s51 offen nt
    v_mfma_f32_16x16x32_bf16 v[28:31], v[76:79], a[124:127], v[28:31]
    s_waitcnt lgkmcnt(2)
    v_exp_f32 v7, v7
    v_mfma_f32_16x16x32_bf16 v[128:131], v[64:67], v[32:35], v[128:131]
    s_add_u32 s43, s43, s59
    ds_read_b64_tr_b16 v[72:73], v94 offset:32768
    v_add_f32 v81, v81, v5
    v_mfma_f32_16x16x32_bf16 v[132:135], v[64:67], v[36:39], v[132:135]
    s_xor_b32 s58, s58, 0xffff8080
    ds_read_b64_tr_b16 v[74:75], v94 offset:40960
    v_add_f32 v81, v81, v6
    v_mfma_f32_16x16x32_bf16 v[136:139], v[64:67], v[40:43], v[136:139]
    ds_read_b64_tr_b16 v[76:77], v95 offset:32768
    v_add_f32 v81, v81, v7
    v_mfma_f32_16x16x32_bf16 v[140:143], v[64:67], v[44:47], v[140:143]
    s_waitcnt lgkmcnt(3)
    ds_read_b64_tr_b16 v[78:79], v95 offset:40960
    v_mfma_f32_16x16x32_bf16 v[144:147], v[68:71], v[32:35], v[144:147]
    s_mov_b32 m0, s35
    ds_read_b64_tr_b16 v[64:65], v96 offset:32768
    v_mfma_f32_16x16x32_bf16 v[148:151], v[68:71], v[36:39], v[148:151]
    ds_read_b64_tr_b16 v[66:67], v96 offset:40960
    v_fma_f32 v8, v8, s28, -v86
    v_mfma_f32_16x16x32_bf16 v[152:155], v[68:71], v[40:43], v[152:155]
    buffer_load_dwordx4 v100, s[12:15], s32 offen lds
    v_mfma_f32_16x16x32_bf16 v[156:159], v[68:71], v[44:47], v[156:159]
    s_waitcnt lgkmcnt(4)
    v_exp_f32 v8, v8
    v_mfma_f32_16x16x32_bf16 v[160:163], v[72:75], v[32:35], v[160:163]
    s_cmp_eq_u32 s46, 2
    ds_read_b64_tr_b16 v[68:69], v97 offset:32768
    v_fma_f32 v10, v10, s28, -v86
    v_mfma_f32_16x16x32_bf16 v[164:167], v[72:75], v[36:39], v[164:167]
    s_cbranch_scc1 L_pf_1
L_pfret_1:
    ds_read_b64_tr_b16 v[70:71], v97 offset:40960
    v_fma_f32 v9, v9, s28, -v86
    v_mfma_f32_16x16x32_bf16 v[168:171], v[72:75], v[40:43], v[168:171]
    v_exp_f32 v9, v9
    v_mfma_f32_16x16x32_bf16 v[172:175], v[72:75], v[44:47], v[172:175]
    s_waitcnt lgkmcnt(4)
    v_exp_f32 v10, v10
    v_mfma_f32_16x16x32_bf16 v[176:179], v[76:79], v[32:35], v[176:179]
    ds_read_b64_tr_b16 v[72:73], v98 offset:32768
    v_fma_f32 v12, v12, s28, -v87
    v_mfma_f32_16x16x32_bf16 v[180:183], v[76:79], v[36:39], v[180:183]
    ds_read_b64_tr_b16 v[74:75], v98 offset:40960
    v_fma_f32 v11, v11, s28, -v86
    v_mfma_f32_16x16x32_bf16 v[184:187], v[76:79], v[40:43], v[184:187]
    v_exp_f32 v11, v11
    v_mfma_f32_16x16x32_bf16 v[188:191], v[76:79], v[44:47], v[188:191]
    s_waitcnt lgkmcnt(4)
    v_exp_f32 v12, v12
    v_mfma_f32_16x16x32_bf16 v[192:195], v[64:67], v[32:35], v[192:195]
    ds_read_b64_tr_b16 v[76:77], v99 offset:32768
    v_add_f32 v82, v82, v8
    v_mfma_f32_16x16x32_bf16 v[196:199], v[64:67], v[36:39], v[196:199]
    ds_read_b64_tr_b16 v[78:79], v99 offset:40960
    v_fma_f32 v13, v13, s28, -v87
    v_mfma_f32_16x16x32_bf16 v[200:203], v[64:67], v[40:43], v[200:203]
    buffer_load_dwordx4 v101, s[12:15], s32 offen offset:1024 lds
    v_mfma_f32_16x16x32_bf16 v[204:207], v[64:67], v[44:47], v[204:207]
    s_waitcnt lgkmcnt(4)
    v_exp_f32 v13, v13
    v_mfma_f32_16x16x32_bf16 v[208:211], v[68:71], v[32:35], v[208:211]
    ds_read_b64_tr_b16 v[64:65], v92 offset:33024
    v_add_f32 v82, v82, v9
    v_mfma_f32_16x16x32_bf16 v[212:215], v[68:71], v[36:39], v[212:215]
    ds_read_b64_tr_b16 v[66:67], v92 offset:41216
    v_fma_f32 v14, v14, s28, -v87
    v_mfma_f32_16x16x32_bf16 v[216:219], v[68:71], v[40:43], v[216:219]
    v_exp_f32 v14, v14
    v_mfma_f32_16x16x32_bf16 v[220:223], v[68:71], v[44:47], v[220:223]
    s_waitcnt lgkmcnt(4)
    v_add_f32 v82, v82, v10
    v_add_f32 v82, v82, v11
    v_mfma_f32_16x16x32_bf16 v[224:227], v[72:75], v[32:35], v[224:227]
    ds_read_b64_tr_b16 v[68:69], v93 offset:33024
    v_add_f32 v83, v83, v12
    v_mfma_f32_16x16x32_bf16 v[228:231], v[72:75], v[36:39], v[228:231]
    ds_read_b64_tr_b16 v[70:71], v93 offset:41216
    v_fma_f32 v15, v15, s28, -v87
    v_mfma_f32_16x16x32_bf16 v[232:235], v[72:75], v[40:43], v[232:235]
    v_exp_f32 v15, v15
    v_mfma_f32_16x16x32_bf16 v[236:239], v[72:75], v[44:47], v[236:239]
    s_waitcnt lgkmcnt(4)
    v_add_f32 v83, v83, v13
    v_add_f32 v83, v83, v14
    v_mfma_f32_16x16x32_bf16 v[240:243], v[76:79], v[32:35], v[240:243]
    ds_read_b64_tr_b16 v[72:73], v94 offset:33024
    v_add_f32 v83, v83, v15
    v_mfma_f32_16x16x32_bf16 v[244:247], v[76:79], v[36:39], v[244:247]
    ds_read_b64_tr_b16 v[74:75], v94 offset:41216
    v_fma_f32 v16, v16, s28, -v84
    v_mfma_f32_16x16x32_bf16 v[248:251], v[76:79], v[40:43], v[248:251]
    buffer_load_dwordx4 v102, s[12:15], s32 offen offset:2048 lds
    v_mfma_f32_16x16x32_bf16 v[252:255], v[76:79], v[44:47], v[252:255]
    s_waitcnt lgkmcnt(4)
    v_exp_f32 v16, v16
    v_mfma_f32_16x16x32_bf16 a[128:131], v[64:67], v[32:35], a[128:131]
    ds_read_b64_tr_b16 v[76:77], v95 offset:33024
    v_fma_f32 v18, v18, s28, -v84
    v_mfma_f32_16x16x32_bf16 a[132:135], v[64:67], v[36:39], a[132:135]
    ds_read_b64_tr_b16 v[78:79], v95 offset:41216
    v_fma_f32 v17, v17, s28, -v84
    v_mfma_f32_16x16x32_bf16 a[136:139], v[64:67], v[40:43], a[136:139]
    v_exp_f32 v17, v17
    v_mfma_f32_16x16x32_bf16 a[140:143], v[64:67], v[44:47], a[140:143]
    s_waitcnt lgkmcnt(4)
    v_exp_f32 v18, v18
    v_mfma_f32_16x16x32_bf16 a[144:147], v[68:71], v[32:35], a[144:147]
    ds_read_b64_tr_b16 v[64:65], v96 offset:33024
    v_add_f32 v80, v80, v16
    v_mfma_f32_16x16x32_bf16 a[148:151], v[68:71], v[36:39], a[148:151]
    ds_read_b64_tr_b16 v[66:67], v96 offset:41216
    v_fma_f32 v19, v19, s28, -v84
    v_mfma_f32_16x16x32_bf16 a[152:155], v[68:71], v[40:43], a[152:155]
    v_add_f32 v80, v80, v18
    v_mfma_f32_16x16x32_bf16 a[156:159], v[68:71], v[44:47], a[156:159]
    s_waitcnt lgkmcnt(4)
    v_exp_f32 v19, v19
    v_mfma_f32_16x16x32_bf16 a[160:163], v[72:75], v[32:35], a[160:163]
    ds_read_b64_tr_b16 v[68:69], v97 offset:33024
    v_add_f32 v80, v80, v17
    v_mfma_f32_16x16x32_bf16 a[164:167], v[72:75], v[36:39], a[164:167]
    ds_read_b64_tr_b16 v[70:71], v97 offset:41216
    v_fma_f32 v20, v20, s28, -v85
    v_mfma_f32_16x16x32_bf16 a[168:171], v[72:75], v[40:43], a[168:171]
    buffer_load_dwordx4 v103, s[12:15], s32 offen offset:3072 lds
    v_mfma_f32_16x16x32_bf16 a[172:175], v[72:75], v[44:47], a[172:175]
    s_waitcnt lgkmcnt(4)
    v_exp_f32 v20, v20
    v_mfma_f32_16x16x32_bf16 a[176:179], v[76:79], v[32:35], a[176:179]
    s_add_u32 s32, s32, 16384
    ds_read_b64_tr_b16 v[72:73], v98 offset:33024
    v_add_f32 v80, v80, v19
    v_mfma_f32_16x16x32_bf16 a[180:183], v[76:79], v[36:39], a[180:183]
    ds_read_b64_tr_b16 v[74:75], v98 offset:41216
    v_fma_f32 v21, v21, s28, -v85
    v_mfma_f32_16x16x32_bf16 a[184:187], v[76:79], v[40:43], a[184:187]
    v_exp_f32 v21, v21
    v_mfma_f32_16x16x32_bf16 a[188:191], v[76:79], v[44:47], a[188:191]
    s_waitcnt lgkmcnt(4)
    v_add_f32 v81, v81, v20
    v_add_f32 v81, v81, v21
    v_mfma_f32_16x16x32_bf16 a[192:195], v[64:67], v[32:35], a[192:195]
    ds_read_b64_tr_b16 v[76:77], v99 offset:33024
    v_fma_f32 v23, v23, s28, -v85
    v_mfma_f32_16x16x32_bf16 a[196:199], v[64:67], v[36:39], a[196:199]
    ds_read_b64_tr_b16 v[78:79], v99 offset:41216
    v_fma_f32 v22, v22, s28, -v85
    v_mfma_f32_16x16x32_bf16 a[200:203], v[64:67], v[40:43], a[200:203]
    v_exp_f32 v22, v22
    v_mfma_f32_16x16x32_bf16 a[204:207], v[64:67], v[44:47], a[204:207]
    s_waitcnt lgkmcnt(4)
    v_mfma_f32_16x16x32_bf16 a[208:211], v[68:71], v[32:35], a[208:211]
    v_exp_f32 v23, v23
    v_mfma_f32_16x16x32_bf16 a[212:215], v[68:71], v[36:39], a[212:215]
    v_mfma_f32_16x16x32_bf16 a[216:219], v[68:71], v[40:43], a[216:219]
    v_mfma_f32_16x16x32_bf16 a[220:223], v[68:71], v[44:47], a[220:223]
    s_waitcnt vmcnt(10) lgkmcnt(0)
    s_barrier
    v_mfma_f32_16x16x32_bf16 a[224:227], v[72:75], v[32:35], a[224:227]
    ds_read_b128 v[64:67], v88 offset:0
    v_add_f32 v81, v81, v22
    v_mfma_f32_16x16x32_bf16 a[228:231], v[72:75], v[36:39], a[228:231]
    s_sub_u32 s46, s46, 1
    ds_read_b128 v[68:71], v89 offset:0
    v_add_f32 v81, v81, v23
    v_mfma_f32_16x16x32_bf16 a[232:235], v[72:75], v[40:43], a[232:235]
    s_cmp_lg_u32 s46, 0
    v_mfma_f32_16x16x32_bf16 a[236:239], v[72:75], v[44:47], a[236:239]
    s_waitcnt lgkmcnt(2)
    v_mfma_f32_16x16x32_bf16 a[240:243], v[76:79], v[32:35], a[240:243]
    v_cvt_pk_bf16_f32 v34, v16, v17
    v_cvt_pk_bf16_f32 v35, v18, v19
    v_mfma_f32_16x16x32_bf16 a[244:247], v[76:79], v[36:39], a[244:247]
    v_cvt_pk_bf16_f32 v32, v0, v1
    v_cvt_pk_bf16_f32 v33, v2, v3
    v_mfma_f32_16x16x32_bf16 a[248:251], v[76:79], v[40:43], a[248:251]
    v_cvt_pk_bf16_f32 v36, v4, v5
    v_cvt_pk_bf16_f32 v37, v6, v7
    v_mfma_f32_16x16x32_bf16 a[252:255], v[76:79], v[44:47], a[252:255]
    s_waitcnt lgkmcnt(0)
    s_cbranch_scc1 L_loop1
L_loop1_end:
L_fe1:
    s_add_u32 s40, s38, 33554432
    v_subrev_u32 v114, 20480, v114
    s_waitcnt vmcnt(6) lgkmcnt(0)
    s_barrier
    ds_read_b64_tr_b16 v[64:65], v92 offset:49152
    ds_read_b64_tr_b16 v[66:67], v92 offset:57344
    ds_read_b64_tr_b16 v[68:69], v93 offset:49152
    ds_read_b64_tr_b16 v[70:71], v93 offset:57344
    ds_read_b64_tr_b16 v[72:73], v94 offset:49152
    ds_read_b64_tr_b16 v[74:75], v94 offset:57344
    v_cvt_pk_bf16_f32 v38, v20, v21
    v_cvt_pk_bf16_f32 v40, v8, v9
    v_cvt_pk_bf16_f32 v41, v10, v11
    v_cvt_pk_bf16_f32 v39, v22, v23
    v_cvt_pk_bf16_f32 v44, v12, v13
    v_cvt_pk_bf16_f32 v45, v14, v15
    v_fma_f32 v24, v24, s28, -v86
    v_exp_f32 v24, v24
    v_fma_f32 v25, v25, s28, -v86
    v_exp_f32 v25, v25
    s_nop 0
    v_cvt_pk_bf16_f32 v42, v24, v25
    v_fma_f32 v26, v26, s28, -v86
    v_fma_f32 v27, v27, s28, -v86
    v_exp_f32 v26, v26
    v_add_f32 v82, v82, v24
    v_add_f32 v82, v82, v25
    v_exp_f32 v27, v27
    s_nop 0
    v_cvt_pk_bf16_f32 v43, v26, v27
    v_add_f32 v82, v82, v26
    v_add_f32 v82, v82, v27
    v_fma_f32 v28, v28, s28, -v87
    v_exp_f32 v28, v28
    v_fma_f32 v29, v29, s28, -v87
    v_add_f32 v83, v83, v28
    v_exp_f32 v29, v29
    s_nop 0
    v_add_f32 v83, v83, v29
    v_cvt_pk_bf16_f32 v46, v28, v29
    v_fma_f32 v30, v30, s28, -v87
    v_exp_f32 v30, v30
    v_fma_f32 v31, v31, s28, -v87
    v_exp_f32 v31, v31
    v_add_f32 v83, v83, v30
    v_cvt_pk_bf16_f32 v47, v30, v31
    v_add_f32 v83, v83, v31
    s_nop 1
    s_waitcnt lgkmcnt(4)
    v_mfma_f32_16x16x32_bf16 v[128:131], v[64:67], v[32:35], v[128:131]
    ds_read_b64_tr_b16 v[76:77], v95 offset:49152
    v_mov_b32 v120, v80
    v_mov_b32 v121, v81
    v_mov_b32 v122, v82
    v_mov_b32 v123, v83
    v_mfma_f32_16x16x32_bf16 v[132:135], v[64:67], v[36:39], v[132:135]
    ds_read_b64_tr_b16 v[78:79], v95 offset:57344
    s_nop 1
    v_permlane16_swap_b32 v80, v120
    v_permlane16_swap_b32 v81, v121
    v_mfma_f32_16x16x32_bf16 v[136:139], v[64:67], v[40:43], v[136:139]
    v_permlane16_swap_b32 v82, v122
    v_permlane16_swap_b32 v83, v123
    s_nop 1
    v_mfma_f32_16x16x32_bf16 v[140:143], v[64:67], v[44:47], v[140:143]
    s_waitcnt lgkmcnt(4)
    v_add_f32 v80, v80, v120
    v_add_f32 v81, v81, v121
    v_add_f32 v82, v82, v122
    v_add_f32 v83, v83, v123
    v_mfma_f32_16x16x32_bf16 v[144:147], v[68:71], v[32:35], v[144:147]
    ds_read_b64_tr_b16 v[64:65], v96 offset:49152
    v_mov_b32 v120, v80
    v_mov_b32 v121, v81
    v_mov_b32 v122, v82
    v_mfma_f32_16x16x32_bf16 v[148:151], v[68:71], v[36:39], v[148:151]
    ds_read_b64_tr_b16 v[66:67], v96 offset:57344
    v_mov_b32 v123, v83
    s_nop 1
    v_permlane32_swap_b32 v80, v120
    v_mfma_f32_16x16x32_bf16 v[152:155], v[68:71], v[40:43], v[152:155]
    v_permlane32_swap_b32 v81, v121
    v_permlane32_swap_b32 v82, v122
    v_permlane32_swap_b32 v83, v123
    s_nop 1
    v_mfma_f32_16x16x32_bf16 v[156:159], v[68:71], v[44:47], v[156:159]
    s_waitcnt lgkmcnt(4)
    v_add_f32 v80, v80, v120
    v_add_f32 v81, v81, v121
    v_add_f32 v82, v82, v122
    v_mfma_f32_16x16x32_bf16 v[160:163], v[72:75], v[32:35], v[160:163]
    ds_read_b64_tr_b16 v[68:69], v97 offset:49152
    v_add_f32 v83, v83, v123
    v_cmp_nge_f32 s[50:51], s29, v80
    v_cmp_nge_f32 s[52:53], s29, v81
    v_mfma_f32_16x16x32_bf16 v[164:167], v[72:75], v[36:39], v[164:167]
    ds_read_b64_tr_b16 v[70:71], v97 offset:57344
    v_cmp_nge_f32 s[54:55], s29, v82
    v_cmp_nge_f32 s[56:57], s29, v83
    v_rcp_f32 v80, v80
    v_rcp_f32 v81, v81
    v_mfma_f32_16x16x32_bf16 v[168:171], v[72:75], v[40:43], v[168:171]
    v_rcp_f32 v82, v82
    v_rcp_f32 v83, v83
    s_nop 0
    v_mfma_f32_16x16x32_bf16 v[172:175], v[72:75], v[44:47], v[172:175]
    s_waitcnt lgkmcnt(4)
    v_mov_b32 v87, v83
    v_mov_b32 v86, v83
    v_mov_b32 v85, v82
    v_mfma_f32_16x16x32_bf16 v[176:179], v[76:79], v[32:35], v[176:179]
    ds_read_b64_tr_b16 v[72:73], v98 offset:49152
    v_mov_b32 v84, v82
    v_mov_b32 v83, v81
    v_mov_b32 v82, v81
    v_mov_b32 v81, v80
    v_mfma_f32_16x16x32_bf16 v[180:183], v[76:79], v[36:39], v[180:183]
    ds_read_b64_tr_b16 v[74:75], v98 offset:57344
    s_lshl_b32 s59, s30, 13
    s_sub_u32 s59, s59, s45
    v_add_u32 v110, s59, v115
    v_mfma_f32_16x16x32_bf16 v[184:187], v[76:79], v[40:43], v[184:187]
    v_add_u32 v111, s59, v116
    v_add_u32 v112, s59, v114
    s_nop 0
    v_mfma_f32_16x16x32_bf16 v[188:191], v[76:79], v[44:47], v[188:191]
    s_waitcnt lgkmcnt(4)
    s_or_b64 s[50:51], s[50:51], s[52:53]
    s_or_b64 s[54:55], s[54:55], s[56:57]
    s_or_b64 s[4:5], s[50:51], s[54:55]
    v_mfma_f32_16x16x32_bf16 v[192:195], v[64:67], v[32:35], v[192:195]
    ds_read_b64_tr_b16 v[76:77], v99 offset:49152
    v_pk_mul_f32 v[128:129], v[128:129], v[80:81]
    v_pk_mul_f32 v[130:131], v[130:131], v[80:81]
    v_pk_mul_f32 v[144:145], v[144:145], v[80:81]
    v_pk_mul_f32 v[146:147], v[146:147], v[80:81]
    v_cvt_pk_bf16_f32 v56, v128, v129
    v_cvt_pk_bf16_f32 v57, v130, v131
    v_cvt_pk_bf16_f32 v58, v144, v145
    v_mfma_f32_16x16x32_bf16 v[196:199], v[64:67], v[36:39], v[196:199]
    ds_read_b64_tr_b16 v[78:79], v99 offset:57344
    v_cvt_pk_bf16_f32 v59, v146, v147
    v_pk_mul_f32 v[160:161], v[160:161], v[80:81]
    v_pk_mul_f32 v[162:163], v[162:163], v[80:81]
    v_permlane16_swap_b32 v56, v58
    v_permlane16_swap_b32 v57, v59
    v_pk_mul_f32 v[176:177], v[176:177], v[80:81]
    v_pk_mul_f32 v[178:179], v[178:179], v[80:81]
    v_mfma_f32_16x16x32_bf16 v[200:203], v[64:67], v[40:43], v[200:203]
    ds_write_b128 v110, v[56:59] offset:0
    v_cvt_pk_bf16_f32 v60, v160, v161
    v_cvt_pk_bf16_f32 v61, v162, v163
    v_cvt_pk_bf16_f32 v62, v176, v177
    v_cvt_pk_bf16_f32 v63, v178, v179
    v_pk_mul_f32 v[132:133], v[132:133], v[82:83]
    v_pk_mul_f32 v[134:135], v[134:135], v[82:83]
    v_mfma_f32_16x16x32_bf16 v[204:207], v[64:67], v[44:47], v[204:207]
    s_waitcnt lgkmcnt(5)
    v_permlane16_swap_b32 v60, v62
    v_permlane16_swap_b32 v61, v63
    v_pk_mul_f32 v[148:149], v[148:149], v[82:83]
    v_pk_mul_f32 v[150:151], v[150:151], v[82:83]
    ds_write_b128 v111, v[60:63] offset:0
    ds_read_b128 v[48:51], v112 offset:0
    ds_read_b128 v[52:55], v112 offset:1024
    v_mfma_f32_16x16x32_bf16 v[208:211], v[68:71], v[32:35], v[208:211]
    ds_read_b64_tr_b16 v[64:65], v92 offset:49408
    v_cvt_pk_bf16_f32 v56, v132, v133
    v_cvt_pk_bf16_f32 v57, v134, v135
    v_cvt_pk_bf16_f32 v58, v148, v149
    v_cvt_pk_bf16_f32 v59, v150, v151
    v_pk_mul_f32 v[164:165], v[164:165], v[82:83]
    v_pk_mul_f32 v[166:167], v[166:167], v[82:83]
    v_permlane16_swap_b32 v56, v58
    v_mfma_f32_16x16x32_bf16 v[212:215], v[68:71], v[36:39], v[212:215]
    ds_read_b64_tr_b16 v[66:67], v92 offset:57600
    v_permlane16_swap_b32 v57, v59
    v_pk_mul_f32 v[180:181], v[180:181], v[82:83]
    s_add_u32 s53, s40, 0
    s_waitcnt lgkmcnt(3)
    buffer_store_dwordx4 v[48:51], v117, s[20:23], s53 offen nt
    v_pk_mul_f32 v[182:183], v[182:183], v[82:83]
    v_mfma_f32_16x16x32_bf16 v[216:219], v[68:71], v[40:43], v[216:219]
    ds_write_b128 v110, v[56:59] offset:2048
    v_cvt_pk_bf16_f32 v60, v164, v165
    v_cvt_pk_bf16_f32 v61, v166, v167
    v_cvt_pk_bf16_f32 v62, v180, v181
    v_cvt_pk_bf16_f32 v63, v182, v183
    s_add_u32 s53, s40, 4096
    s_waitcnt lgkmcnt(3)
    v_mfma_f32_16x16x32_bf16 v[220:223], v[68:71], v[44:47], v[220:223]
    s_waitcnt lgkmcnt(9)
    buffer_store_dwordx4 v[52:55], v117, s[20:23], s53 offen nt
    v_pk_mul_f32 v[136:137], v[136:137], v[84:85]
    v_pk_mul_f32 v[138:139], v[138:139], v[84:85]
    v_permlane16_swap_b32 v60, v62
    v_permlane16_swap_b32 v61, v63
    v_pk_mul_f32 v[152:153], v[152:153], v[84:85]
    v_pk_mul_f32 v[154:155], v[154:155], v[84:85]
    v_mfma_f32_16x16x32_bf16 v[224:227], v[72:75], v[32:35], v[224:227]
    ds_read_b64_tr_b16 v[68:69], v93 offset:49408
    ds_write_b128 v111, v[60:63] offset:2048
    ds_read_b128 v[48:51], v112 offset:2048
    ds_read_b128 v[52:55], v112 offset:3072
    v_cvt_pk_bf16_f32 v56, v136, v137
    v_cvt_pk_bf16_f32 v57, v138, v139
    v_cvt_pk_bf16_f32 v58, v152, v153
    v_cvt_pk_bf16_f32 v59, v154, v155
    v_mfma_f32_16x16x32_bf16 v[228:231], v[72:75], v[36:39], v[228:231]
    ds_read_b64_tr_b16 v[70:71], v93 offset:57600
    v_pk_mul_f32 v[168:169], v[168:169], v[84:85]
    v_pk_mul_f32 v[170:171], v[170:171], v[84:85]
    v_permlane16_swap_b32 v56, v58
    v_permlane16_swap_b32 v57, v59
    v_pk_mul_f32 v[184:185], v[184:185], v[84:85]
    s_add_u32 s53, s40, 8192
    s_waitcnt lgkmcnt(2)
    v_mfma_f32_16x16x32_bf16 v[232:235], v[72:75], v[40:43], v[232:235]
    buffer_store_dwordx4 v[48:51], v117, s[20:23], s53 offen nt
    v_pk_mul_f32 v[186:187], v[186:187], v[84:85]
    ds_write_b128 v110, v[56:59] offset:4096
    v_cvt_pk_bf16_f32 v60, v168, v169
    v_cvt_pk_bf16_f32 v61, v170, v171
    v_cvt_pk_bf16_f32 v62, v184, v185
    v_mfma_f32_16x16x32_bf16 v[236:239], v[72:75], v[44:47], v[236:239]
    s_waitcnt lgkmcnt(13)
    v_cvt_pk_bf16_f32 v63, v186, v187
    s_add_u32 s53, s40, 12288
    s_waitcnt lgkmcnt(2)
    buffer_store_dwordx4 v[52:55], v117, s[20:23], s53 offen nt
    v_pk_mul_f32 v[140:141], v[140:141], v[86:87]
    v_pk_mul_f32 v[142:143], v[142:143], v[86:87]
    v_permlane16_swap_b32 v60, v62
    v_mfma_f32_16x16x32_bf16 v[240:243], v[76:79], v[32:35], v[240:243]
    ds_read_b64_tr_b16 v[72:73], v94 offset:49408
    v_permlane16_swap_b32 v61, v63
    v_pk_mul_f32 v[156:157], v[156:157], v[86:87]
    v_pk_mul_f32 v[158:159], v[158:159], v[86:87]
    ds_write_b128 v111, v[60:63] offset:4096
    ds_read_b128 v[48:51], v112 offset:4096
    ds_read_b128 v[52:55], v112 offset:5120
    v_cvt_pk_bf16_f32 v56, v140, v141
    v_mfma_f32_16x16x32_bf16 v[244:247], v[76:79], v[36:39], v[244:247]
    ds_read_b64_tr_b16 v[74:75], v94 offset:57600
    v_cvt_pk_bf16_f32 v57, v142, v143
    v_cvt_pk_bf16_f32 v58, v156, v157
    v_cvt_pk_bf16_f32 v59, v158, v159
    v_pk_mul_f32 v[172:173], v[172:173], v[86:87]
    v_pk_mul_f32 v[174:175], v[174:175], v[86:87]
    v_permlane16_swap_b32 v56, v58
    v_permlane16_swap_b32 v57, v59
    v_mfma_f32_16x16x32_bf16 v[248:251], v[76:79], v[40:43], v[248:251]
    v_pk_mul_f32 v[188:189], v[188:189], v[86:87]
    s_add_u32 s53, s40, 16384
    s_waitcnt lgkmcnt(2)
    buffer_store_dwordx4 v[48:51], v117, s[20:23], s53 offen nt
    v_pk_mul_f32 v[190:191], v[190:191], v[86:87]
    ds_write_b128 v110, v[56:59] offset:6144
    v_cvt_pk_bf16_f32 v60, v172, v173
    v_mfma_f32_16x16x32_bf16 v[252:255], v[76:79], v[44:47], v[252:255]
    s_waitcnt lgkmcnt(13)
    v_cvt_pk_bf16_f32 v61, v174, v175
    v_cvt_pk_bf16_f32 v62, v188, v189
    v_cvt_pk_bf16_f32 v63, v190, v191
    s_add_u32 s53, s40, 20480
    s_waitcnt lgkmcnt(2)
    buffer_store_dwordx4 v[52:55], v117, s[20:23], s53 offen nt
    v_mfma_f32_16x16x32_bf16 a[128:131], v[64:67], v[32:35], a[128:131]
    ds_read_b64_tr_b16 v[76:77], v95 offset:49408
    v_pk_mul_f32 v[192:193], v[192:193], v[80:81]
    v_pk_mul_f32 v[194:195], v[194:195], v[80:81]
    v_permlane16_swap_b32 v60, v62
    v_permlane16_swap_b32 v61, v63
    v_pk_mul_f32 v[208:209], v[208:209], v[80:81]
    v_pk_mul_f32 v[210:211], v[210:211], v[80:81]
    ds_write_b128 v111, v[60:63] offset:6144
    ds_read_b128 v[48:51], v112 offset:6144
    v_mfma_f32_16x16x32_bf16 a[132:135], v[64:67], v[36:39], a[132:135]
    ds_read_b64_tr_b16 v[78:79], v95 offset:57600
    ds_read_b128 v[52:55], v112 offset:7168
    v_cvt_pk_bf16_f32 v56, v192, v193
    v_cvt_pk_bf16_f32 v57, v194, v195
    v_cvt_pk_bf16_f32 v58, v208, v209
    v_cvt_pk_bf16_f32 v59, v210, v211
    v_pk_mul_f32 v[224:225], v[224:225], v[80:81]
    v_pk_mul_f32 v[226:227], v[226:227], v[80:81]
    v_mfma_f32_16x16x32_bf16 a[136:139], v[64:67], v[40:43], a[136:139]
    v_permlane16_swap_b32 v56, v58
    v_permlane16_swap_b32 v57, v59
    v_pk_mul_f32 v[240:241], v[240:241], v[80:81]
    s_add_u32 s53, s40, 24576
    s_waitcnt lgkmcnt(2)
    buffer_store_dwordx4 v[48:51], v117, s[20:23], s53 offen nt
    v_pk_mul_f32 v[242:243], v[242:243], v[80:81]
    ds_write_b128 v115, v[56:59] offset:0
    v_mfma_f32_16x16x32_bf16 a[140:143], v[64:67], v[44:47], a[140:143]
    s_waitcnt lgkmcnt(13)
    v_cvt_pk_bf16_f32 v60, v224, v225
    v_cvt_pk_bf16_f32 v61, v226, v227
    v_cvt_pk_bf16_f32 v62, v240, v241
    v_cvt_pk_bf16_f32 v63, v242, v243
    s_add_u32 s53, s40, 28672
    s_waitcnt lgkmcnt(1)
    buffer_store_dwordx4 v[52:55], v117, s[20:23], s53 offen nt
    v_mfma_f32_16x16x32_bf16 a[144:147], v[68:71], v[32:35], a[144:147]
    ds_read_b64_tr_b16 v[64:65], v96 offset:49408
    v_pk_mul_f32 v[196:197], v[196:197], v[82:83]
    v_pk_mul_f32 v[198:199], v[198:199], v[82:83]
    v_permlane16_swap_b32 v60, v62
    v_permlane16_swap_b32 v61, v63
    v_pk_mul_f32 v[212:213], v[212:213], v[82:83]
    v_pk_mul_f32 v[214:215], v[214:215], v[82:83]
    ds_write_b128 v116, v[60:63] offset:0
    ds_read_b128 v[48:51], v114 offset:0
    v_mfma_f32_16x16x32_bf16 a[148:151], v[68:71], v[36:39], a[148:151]
    ds_read_b64_tr_b16 v[66:67], v96 offset:57600
    ds_read_b128 v[52:55], v114 offset:1024
    v_cvt_pk_bf16_f32 v56, v196, v197
    v_cvt_pk_bf16_f32 v57, v198, v199
    v_cvt_pk_bf16_f32 v58, v212, v213
    v_cvt_pk_bf16_f32 v59, v214, v215
    v_pk_mul_f32 v[228:229], v[228:229], v[82:83]
    v_pk_mul_f32 v[230:231], v[230:231], v[82:83]
    v_mfma_f32_16x16x32_bf16 a[152:155], v[68:71], v[40:43], a[152:155]
    v_permlane16_swap_b32 v56, v58
    v_permlane16_swap_b32 v57, v59
    v_pk_mul_f32 v[244:245], v[244:245], v[82:83]
    s_add_u32 s53, s40, 0
    s_waitcnt lgkmcnt(2)
    buffer_store_dwordx4 v[48:51], v117, s[20:23], s53 offen offset:128 nt
    v_pk_mul_f32 v[246:247], v[246:247], v[82:83]
    ds_write_b128 v115, v[56:59] offset:2048
    v_mfma_f32_16x16x32_bf16 a[156:159], v[68:71], v[44:47], a[156:159]
    s_waitcnt lgkmcnt(13)
    v_cvt_pk_bf16_f32 v60, v228, v229
    v_cvt_pk_bf16_f32 v61, v230, v231
    v_cvt_pk_bf16_f32 v62, v244, v245
    v_cvt_pk_bf16_f32 v63, v246, v247
    s_add_u32 s53, s40, 4096
    s_waitcnt lgkmcnt(1)
    buffer_store_dwordx4 v[52:55], v117, s[20:23], s53 offen offset:128 nt
    v_mfma_f32_16x16x32_bf16 a[160:163], v[72:75], v[32:35], a[160:163]
    ds_read_b64_tr_b16 v[68:69], v97 offset:49408
    v_pk_mul_f32 v[200:201], v[200:201], v[84:85]
    v_pk_mul_f32 v[202:203], v[202:203], v[84:85]
    v_permlane16_swap_b32 v60, v62
    v_permlane16_swap_b32 v61, v63
    v_pk_mul_f32 v[216:217], v[216:217], v[84:85]
    v_pk_mul_f32 v[218:219], v[218:219], v[84:85]
    ds_write_b128 v116, v[60:63] offset:2048
    ds_read_b128 v[48:51], v114 offset:2048
    v_mfma_f32_16x16x32_bf16 a[164:167], v[72:75], v[36:39], a[164:167]
    ds_read_b64_tr_b16 v[70:71], v97 offset:57600
    ds_read_b128 v[52:55], v114 offset:3072
    v_cvt_pk_bf16_f32 v56, v200, v201
    v_cvt_pk_bf16_f32 v57, v202, v203
    v_cvt_pk_bf16_f32 v58, v216, v217
    v_cvt_pk_bf16_f32 v59, v218, v219
    v_pk_mul_f32 v[232:233], v[232:233], v[84:85]
    v_pk_mul_f32 v[234:235], v[234:235], v[84:85]
    v_mfma_f32_16x16x32_bf16 a[168:171], v[72:75], v[40:43], a[168:171]
    v_permlane16_swap_b32 v56, v58
    v_permlane16_swap_b32 v57, v59
    v_pk_mul_f32 v[248:249], v[248:249], v[84:85]
    s_add_u32 s53, s40, 8192
    s_waitcnt lgkmcnt(2)
    buffer_store_dwordx4 v[48:51], v117, s[20:23], s53 offen offset:128 nt
    v_pk_mul_f32 v[250:251], v[250:251], v[84:85]
    ds_write_b128 v115, v[56:59] offset:4096
    v_mfma_f32_16x16x32_bf16 a[172:175], v[72:75], v[44:47], a[172:175]
    s_waitcnt lgkmcnt(14)
    v_cvt_pk_bf16_f32 v60, v232, v233
    v_cvt_pk_bf16_f32 v61, v234, v235
    v_cvt_pk_bf16_f32 v62, v248, v249
    v_cvt_pk_bf16_f32 v63, v250, v251
    s_add_u32 s53, s40, 12288
    s_waitcnt lgkmcnt(1)
    buffer_store_dwordx4 v[52:55], v117, s[20:23], s53 offen offset:128 nt
    v_mfma_f32_16x16x32_bf16 a[176:179], v[76:79], v[32:35], a[176:179]
    ds_read_b64_tr_b16 v[72:73], v98 offset:49408
    v_pk_mul_f32 v[204:205], v[204:205], v[86:87]
    v_pk_mul_f32 v[206:207], v[206:207], v[86:87]
    v_permlane16_swap_b32 v60, v62
    v_permlane16_swap_b32 v61, v63
    v_pk_mul_f32 v[220:221], v[220:221], v[86:87]
    v_pk_mul_f32 v[222:223], v[222:223], v[86:87]
    ds_write_b128 v116, v[60:63] offset:4096
    ds_read_b128 v[48:51], v114 offset:4096
    v_mfma_f32_16x16x32_bf16 a[180:183], v[76:79], v[36:39], a[180:183]
    ds_read_b64_tr_b16 v[74:75], v98 offset:57600
    ds_read_b128 v[52:55], v114 offset:5120
    v_cvt_pk_bf16_f32 v56, v204, v205
    v_cvt_pk_bf16_f32 v57, v206, v207
    v_cvt_pk_bf16_f32 v58, v220, v221
    v_cvt_pk_bf16_f32 v59, v222, v223
    v_pk_mul_f32 v[236:237], v[236:237], v[86:87]
    v_pk_mul_f32 v[238:239], v[238:239], v[86:87]
    v_mfma_f32_16x16x32_bf16 a[184:187], v[76:79], v[40:43], a[184:187]
    v_permlane16_swap_b32 v56, v58
    v_permlane16_swap_b32 v57, v59
    v_pk_mul_f32 v[252:253], v[252:253], v[86:87]
    s_add_u32 s53, s40, 16384
    s_waitcnt lgkmcnt(2)
    buffer_store_dwordx4 v[48:51], v117, s[20:23], s53 offen offset:128 nt
    v_pk_mul_f32 v[254:255], v[254:255], v[86:87]
    ds_write_b128 v115, v[56:59] offset:6144
    v_mfma_f32_16x16x32_bf16 a[188:191], v[76:79], v[44:47], a[188:191]
    s_waitcnt lgkmcnt(14)
    v_cvt_pk_bf16_f32 v60, v236, v237
    v_cvt_pk_bf16_f32 v61, v238, v239
    v_cvt_pk_bf16_f32 v62, v252, v253
    v_cvt_pk_bf16_f32 v63, v254, v255
    s_add_u32 s53, s40, 20480
    s_waitcnt lgkmcnt(1)
    buffer_store_dwordx4 v[52:55], v117, s[20:23], s53 offen offset:128 nt
    v_mfma_f32_16x16x32_bf16 a[192:195], v[64:67], v[32:35], a[192:195]
    ds_read_b64_tr_b16 v[76:77], v99 offset:49408
    v_accvgpr_read_b32 v120, a128
    v_accvgpr_read_b32 v121, a129
    v_permlane16_swap_b32 v60, v62
    v_permlane16_swap_b32 v61, v63
    v_accvgpr_read_b32 v122, a130
    v_accvgpr_read_b32 v123, a131
    ds_write_b128 v116, v[60:63] offset:6144
    ds_read_b128 v[48:51], v114 offset:6144
    ds_read_b128 v[52:55], v114 offset:7168
    v_accvgpr_read_b32 v124, a144
    v_accvgpr_read_b32 v125, a145
    v_accvgpr_read_b32 v126, a146
    v_mfma_f32_16x16x32_bf16 a[196:199], v[64:67], v[36:39], a[196:199]
    ds_read_b64_tr_b16 v[78:79], v99 offset:57600
    v_accvgpr_read_b32 v127, a147
    v_pk_mul_f32 v[120:121], v[120:121], v[80:81]
    v_pk_mul_f32 v[122:123], v[122:123], v[80:81]
    v_pk_mul_f32 v[124:125], v[124:125], v[80:81]
    v_pk_mul_f32 v[126:127], v[126:127], v[80:81]
    v_cvt_pk_bf16_f32 v56, v120, v121
    v_cvt_pk_bf16_f32 v57, v122, v123
    v_cvt_pk_bf16_f32 v58, v124, v125
    v_cvt_pk_bf16_f32 v59, v126, v127
    v_accvgpr_read_b32 v0, a160
    v_accvgpr_read_b32 v1, a161
    v_mfma_f32_16x16x32_bf16 a[200:203], v[64:67], v[40:43], a[200:203]
    v_permlane16_swap_b32 v56, v58
    v_permlane16_swap_b32 v57, v59
    v_accvgpr_read_b32 v2, a162
    v_accvgpr_read_b32 v3, a163
    ds_write_b128 v115, v[56:59] offset:8192
    v_accvgpr_read_b32 v4, a176
    v_accvgpr_read_b32 v5, a177
    s_add_u32 s53, s40, 24576
    s_waitcnt lgkmcnt(3)
    buffer_store_dwordx4 v[48:51], v117, s[20:23], s53 offen offset:128 nt
    v_accvgpr_read_b32 v6, a178
    v_accvgpr_read_b32 v7, a179
    v_mfma_f32_16x16x32_bf16 a[204:207], v[64:67], v[44:47], a[204:207]
    s_waitcnt lgkmcnt(14)
    v_pk_mul_f32 v[0:1], v[0:1], v[80:81]
    v_pk_mul_f32 v[2:3], v[2:3], v[80:81]
    v_pk_mul_f32 v[4:5], v[4:5], v[80:81]
    v_pk_mul_f32 v[6:7], v[6:7], v[80:81]
    v_cvt_pk_bf16_f32 v60, v0, v1
    v_cvt_pk_bf16_f32 v61, v2, v3
    v_cvt_pk_bf16_f32 v62, v4, v5
    v_cvt_pk_bf16_f32 v63, v6, v7
    s_add_u32 s53, s40, 28672
    s_waitcnt lgkmcnt(2)
    buffer_store_dwordx4 v[52:55], v117, s[20:23], s53 offen offset:128 nt
    v_mfma_f32_16x16x32_bf16 a[208:211], v[68:71], v[32:35], a[208:211]
    v_accvgpr_read_b32 v120, a132
    v_accvgpr_read_b32 v121, a133
    v_permlane16_swap_b32 v60, v62
    v_permlane16_swap_b32 v61, v63
    v_accvgpr_read_b32 v122, a134
    v_accvgpr_read_b32 v123, a135
    ds_write_b128 v116, v[60:63] offset:8192
    ds_read_b128 v[48:51], v114 offset:8192
    ds_read_b128 v[52:55], v114 offset:9216
    v_accvgpr_read_b32 v124, a148
    v_accvgpr_read_b32 v125, a149
    v_accvgpr_read_b32 v126, a150
    v_mfma_f32_16x16x32_bf16 a[212:215], v[68:71], v[36:39], a[212:215]
    v_accvgpr_read_b32 v127, a151
    v_pk_mul_f32 v[120:121], v[120:121], v[82:83]
    v_pk_mul_f32 v[122:123], v[122:123], v[82:83]
    v_pk_mul_f32 v[124:125], v[124:125], v[82:83]
    v_pk_mul_f32 v[126:127], v[126:127], v[82:83]
    v_cvt_pk_bf16_f32 v56, v120, v121
    v_cvt_pk_bf16_f32 v57, v122, v123
    v_cvt_pk_bf16_f32 v58, v124, v125
    v_cvt_pk_bf16_f32 v59, v126, v127
    v_accvgpr_read_b32 v0, a164
    v_accvgpr_read_b32 v1, a165
    v_mfma_f32_16x16x32_bf16 a[216:219], v[68:71], v[40:43], a[216:219]
    v_permlane16_swap_b32 v56, v58
    v_permlane16_swap_b32 v57, v59
    v_accvgpr_read_b32 v2, a166
    v_accvgpr_read_b32 v3, a167
    ds_write_b128 v115, v[56:59] offset:10240
    v_accvgpr_read_b32 v4, a180
    v_accvgpr_read_b32 v5, a181
    s_add_u32 s53, s40, 0
    s_waitcnt lgkmcnt(2)
    buffer_store_dwordx4 v[48:51], v117, s[20:23], s53 offen offset:256 nt
    v_accvgpr_read_b32 v6, a182
    v_accvgpr_read_b32 v7, a183
    v_mfma_f32_16x16x32_bf16 a[220:223], v[68:71], v[44:47], a[220:223]
    s_waitcnt lgkmcnt(12)
    v_pk_mul_f32 v[0:1], v[0:1], v[82:83]
    v_pk_mul_f32 v[2:3], v[2:3], v[82:83]
    v_pk_mul_f32 v[4:5], v[4:5], v[82:83]
    v_pk_mul_f32 v[6:7], v[6:7], v[82:83]
    v_cvt_pk_bf16_f32 v60, v0, v1
    v_cvt_pk_bf16_f32 v61, v2, v3
    v_cvt_pk_bf16_f32 v62, v4, v5
    v_cvt_pk_bf16_f32 v63, v6, v7
    s_add_u32 s53, s40, 4096
    s_waitcnt lgkmcnt(1)
    buffer_store_dwordx4 v[52:55], v117, s[20:23], s53 offen offset:256 nt
    v_mfma_f32_16x16x32_bf16 a[224:227], v[72:75], v[32:35], a[224:227]
    v_accvgpr_read_b32 v120, a136
    v_accvgpr_read_b32 v121, a137
    v_permlane16_swap_b32 v60, v62
    v_permlane16_swap_b32 v61, v63
    v_accvgpr_read_b32 v122, a138
    v_accvgpr_read_b32 v123, a139
    ds_write_b128 v116, v[60:63] offset:10240
    ds_read_b128 v[48:51], v114 offset:10240
    ds_read_b128 v[52:55], v114 offset:11264
    v_accvgpr_read_b32 v124, a152
    v_accvgpr_read_b32 v125, a153
    v_accvgpr_read_b32 v126, a154
    v_mfma_f32_16x16x32_bf16 a[228:231], v[72:75], v[36:39], a[228:231]
    v_accvgpr_read_b32 v127, a155
    v_pk_mul_f32 v[120:121], v[120:121], v[84:85]
    v_pk_mul_f32 v[122:123], v[122:123], v[84:85]
    v_pk_mul_f32 v[124:125], v[124:125], v[84:85]
    v_pk_mul_f32 v[126:127], v[126:127], v[84:85]
    v_cvt_pk_bf16_f32 v56, v120, v121
    v_cvt_pk_bf16_f32 v57, v122, v123
    v_cvt_pk_bf16_f32 v58, v124, v125
    v_cvt_pk_bf16_f32 v59, v126, v127
    v_accvgpr_read_b32 v0, a168
    v_accvgpr_read_b32 v1, a169
    v_mfma_f32_16x16x32_bf16 a[232:235], v[72:75], v[40:43], a[232:235]
    v_permlane16_swap_b32 v56, v58
    v_permlane16_swap_b32 v57, v59
    v_accvgpr_read_b32 v2, a170
    v_accvgpr_read_b32 v3, a171
    ds_write_b128 v115, v[56:59] offset:12288
    v_accvgpr_read_b32 v4, a184
    v_accvgpr_read_b32 v5, a185
    s_add_u32 s53, s40, 8192
    s_waitcnt lgkmcnt(2)
    buffer_store_dwordx4 v[48:51], v117, s[20:23], s53 offen offset:256 nt
    v_accvgpr_read_b32 v6, a186
    v_accvgpr_read_b32 v7, a187
    v_mfma_f32_16x16x32_bf16 a[236:239], v[72:75], v[44:47], a[236:239]
    s_waitcnt lgkmcnt(9)
    v_pk_mul_f32 v[0:1], v[0:1], v[84:85]
    v_pk_mul_f32 v[2:3], v[2:3], v[84:85]
    v_pk_mul_f32 v[4:5], v[4:5], v[84:85]
    v_pk_mul_f32 v[6:7], v[6:7], v[84:85]
    v_cvt_pk_bf16_f32 v60, v0, v1
    v_cvt_pk_bf16_f32 v61, v2, v3
    v_cvt_pk_bf16_f32 v62, v4, v5
    v_cvt_pk_bf16_f32 v63, v6, v7
    s_add_u32 s53, s40, 12288
    s_waitcnt lgkmcnt(1)
    buffer_store_dwordx4 v[52:55], v117, s[20:23], s53 offen offset:256 nt
    v_mfma_f32_16x16x32_bf16 a[240:243], v[76:79], v[32:35], a[240:243]
    v_accvgpr_read_b32 v120, a140
    v_accvgpr_read_b32 v121, a141
    v_permlane16_swap_b32 v60, v62
    v_permlane16_swap_b32 v61, v63
    v_accvgpr_read_b32 v122, a142
    v_accvgpr_read_b32 v123, a143
    ds_write_b128 v116, v[60:63] offset:12288
    ds_read_b128 v[48:51], v114 offset:12288
    ds_read_b128 v[52:55], v114 offset:13312
    v_accvgpr_read_b32 v124, a156
    v_accvgpr_read_b32 v125, a157
    v_accvgpr_read_b32 v126, a158
    v_mfma_f32_16x16x32_bf16 a[244:247], v[76:79], v[36:39], a[244:247]
    v_accvgpr_read_b32 v127, a159
    v_pk_mul_f32 v[120:121], v[120:121], v[86:87]
    v_pk_mul_f32 v[122:123], v[122:123], v[86:87]
    v_pk_mul_f32 v[124:125], v[124:125], v[86:87]
    v_pk_mul_f32 v[126:127], v[126:127], v[86:87]
    v_cvt_pk_bf16_f32 v56, v120, v121
    v_cvt_pk_bf16_f32 v57, v122, v123
    v_cvt_pk_bf16_f32 v58, v124, v125
    v_cvt_pk_bf16_f32 v59, v126, v127
    v_accvgpr_read_b32 v0, a172
    v_accvgpr_read_b32 v1, a173
    v_mfma_f32_16x16x32_bf16 a[248:251], v[76:79], v[40:43], a[248:251]
    v_permlane16_swap_b32 v56, v58
    v_permlane16_swap_b32 v57, v59
    v_accvgpr_read_b32 v2, a174
    v_accvgpr_read_b32 v3, a175
    ds_write_b128 v115, v[56:59] offset:14336
    v_accvgpr_read_b32 v4, a188
    v_accvgpr_read_b32 v5, a189
    s_add_u32 s53, s40, 16384
    s_waitcnt lgkmcnt(2)
    buffer_store_dwordx4 v[48:51], v117, s[20:23], s53 offen offset:256 nt
    v_accvgpr_read_b32 v6, a190
    v_accvgpr_read_b32 v7, a191
    v_mfma_f32_16x16x32_bf16 a[252:255], v[76:79], v[44:47], a[252:255]
    v_pk_mul_f32 v[0:1], v[0:1], v[86:87]
    v_pk_mul_f32 v[2:3], v[2:3], v[86:87]
    v_pk_mul_f32 v[4:5], v[4:5], v[86:87]
    v_pk_mul_f32 v[6:7], v[6:7], v[86:87]
    v_cvt_pk_bf16_f32 v60, v0, v1
    v_cvt_pk_bf16_f32 v61, v2, v3
    v_cvt_pk_bf16_f32 v62, v4, v5
    v_cvt_pk_bf16_f32 v63, v6, v7
    s_add_u32 s53, s40, 20480
    s_waitcnt lgkmcnt(1)
    buffer_store_dwordx4 v[52:55], v117, s[20:23], s53 offen offset:256 nt
    v_accvgpr_read_b32 v120, a192
    v_accvgpr_read_b32 v121, a193
    v_permlane16_swap_b32 v60, v62
    v_permlane16_swap_b32 v61, v63
    v_accvgpr_read_b32 v122, a194
    v_accvgpr_read_b32 v123, a195
    ds_write_b128 v116, v[60:63] offset:14336
    ds_read_b128 v[48:51], v114 offset:14336
    ds_read_b128 v[52:55], v114 offset:15360
    v_accvgpr_read_b32 v124, a208
    v_accvgpr_read_b32 v125, a209
    v_accvgpr_read_b32 v126, a210
    v_accvgpr_read_b32 v127, a211
    v_pk_mul_f32 v[120:121], v[120:121], v[80:81]
    v_pk_mul_f32 v[122:123], v[122:123], v[80:81]
    v_pk_mul_f32 v[124:125], v[124:125], v[80:81]
    v_pk_mul_f32 v[126:127], v[126:127], v[80:81]
    v_cvt_pk_bf16_f32 v56, v120, v121
    v_cvt_pk_bf16_f32 v57, v122, v123
    v_cvt_pk_bf16_f32 v58, v124, v125
    v_cvt_pk_bf16_f32 v59, v126, v127
    v_accvgpr_read_b32 v0, a224
    v_accvgpr_read_b32 v1, a225
    v_permlane16_swap_b32 v56, v58
    v_permlane16_swap_b32 v57, v59
    v_accvgpr_read_b32 v2, a226
    v_accvgpr_read_b32 v3, a227
    ds_write_b128 v115, v[56:59] offset:16384
    v_accvgpr_read_b32 v4, a240
    v_accvgpr_read_b32 v5, a241
    s_add_u32 s53, s40, 24576
    s_waitcnt lgkmcnt(2)
    buffer_store_dwordx4 v[48:51], v117, s[20:23], s53 offen offset:256 nt
    v_accvgpr_read_b32 v6, a242
    v_accvgpr_read_b32 v7, a243
    v_pk_mul_f32 v[0:1], v[0:1], v[80:81]
    v_pk_mul_f32 v[2:3], v[2:3], v[80:81]
    v_pk_mul_f32 v[4:5], v[4:5], v[80:81]
    v_pk_mul_f32 v[6:7], v[6:7], v[80:81]
    v_cvt_pk_bf16_f32 v60, v0, v1
    v_cvt_pk_bf16_f32 v61, v2, v3
    v_cvt_pk_bf16_f32 v62, v4, v5
    v_cvt_pk_bf16_f32 v63, v6, v7
    s_add_u32 s53, s40, 28672
    s_waitcnt lgkmcnt(1)
    buffer_store_dwordx4 v[52:55], v117, s[20:23], s53 offen offset:256 nt
    v_accvgpr_read_b32 v120, a196
    v_accvgpr_read_b32 v121, a197
    v_permlane16_swap_b32 v60, v62
    v_permlane16_swap_b32 v61, v63
    v_accvgpr_read_b32 v122, a198
    v_accvgpr_read_b32 v123, a199
    ds_write_b128 v116, v[60:63] offset:16384
    ds_read_b128 v[48:51], v114 offset:16384
    ds_read_b128 v[52:55], v114 offset:17408
    v_accvgpr_read_b32 v124, a212
    v_accvgpr_read_b32 v125, a213
    v_accvgpr_read_b32 v126, a214
    v_accvgpr_read_b32 v127, a215
    v_pk_mul_f32 v[120:121], v[120:121], v[82:83]
    v_pk_mul_f32 v[122:123], v[122:123], v[82:83]
    v_pk_mul_f32 v[124:125], v[124:125], v[82:83]
    v_pk_mul_f32 v[126:127], v[126:127], v[82:83]
    v_cvt_pk_bf16_f32 v56, v120, v121
    v_cvt_pk_bf16_f32 v57, v122, v123
    v_cvt_pk_bf16_f32 v58, v124, v125
    v_cvt_pk_bf16_f32 v59, v126, v127
    v_accvgpr_read_b32 v0, a228
    v_accvgpr_read_b32 v1, a229
    v_permlane16_swap_b32 v56, v58
    v_permlane16_swap_b32 v57, v59
    v_accvgpr_read_b32 v2, a230
    v_accvgpr_read_b32 v3, a231
    ds_write_b128 v115, v[56:59] offset:18432
    v_accvgpr_read_b32 v4, a244
    v_accvgpr_read_b32 v5, a245
    s_add_u32 s53, s40, 0
    s_waitcnt lgkmcnt(2)
    buffer_store_dwordx4 v[48:51], v117, s[20:23], s53 offen offset:384 nt
    v_accvgpr_read_b32 v6, a246
    v_accvgpr_read_b32 v7, a247
    v_pk_mul_f32 v[0:1], v[0:1], v[82:83]
    v_pk_mul_f32 v[2:3], v[2:3], v[82:83]
    v_pk_mul_f32 v[4:5], v[4:5], v[82:83]
    v_pk_mul_f32 v[6:7], v[6:7], v[82:83]
    v_cvt_pk_bf16_f32 v60, v0, v1
    v_cvt_pk_bf16_f32 v61, v2, v3
    v_cvt_pk_bf16_f32 v62, v4, v5
    v_cvt_pk_bf16_f32 v63, v6, v7
    s_add_u32 s53, s40, 4096
    s_waitcnt lgkmcnt(1)
    buffer_store_dwordx4 v[52:55], v117, s[20:23], s53 offen offset:384 nt
    v_accvgpr_read_b32 v120, a200
    v_accvgpr_read_b32 v121, a201
    v_permlane16_swap_b32 v60, v62
    v_permlane16_swap_b32 v61, v63
    v_accvgpr_read_b32 v122, a202
    v_accvgpr_read_b32 v123, a203
    ds_write_b128 v116, v[60:63] offset:18432
    ds_read_b128 v[48:51], v114 offset:18432
    ds_read_b128 v[52:55], v114 offset:19456
    v_accvgpr_read_b32 v124, a216
    v_accvgpr_read_b32 v125, a217
    v_accvgpr_read_b32 v126, a218
    v_accvgpr_read_b32 v127, a219
    v_pk_mul_f32 v[120:121], v[120:121], v[84:85]
    v_pk_mul_f32 v[122:123], v[122:123], v[84:85]
    v_pk_mul_f32 v[124:125], v[124:125], v[84:85]
    v_pk_mul_f32 v[126:127], v[126:127], v[84:85]
    v_cvt_pk_bf16_f32 v56, v120, v121
    v_cvt_pk_bf16_f32 v57, v122, v123
    v_cvt_pk_bf16_f32 v58, v124, v125
    v_cvt_pk_bf16_f32 v59, v126, v127
    v_accvgpr_read_b32 v0, a232
    v_accvgpr_read_b32 v1, a233
    v_permlane16_swap_b32 v56, v58
    v_permlane16_swap_b32 v57, v59
    v_accvgpr_read_b32 v2, a234
    v_accvgpr_read_b32 v3, a235
    ds_write_b128 v115, v[56:59] offset:20480
    v_accvgpr_read_b32 v4, a248
    v_accvgpr_read_b32 v5, a249
    s_add_u32 s53, s40, 8192
    s_waitcnt lgkmcnt(2)
    buffer_store_dwordx4 v[48:51], v117, s[20:23], s53 offen offset:384 nt
    v_accvgpr_read_b32 v6, a250
    v_accvgpr_read_b32 v7, a251
    v_pk_mul_f32 v[0:1], v[0:1], v[84:85]
    v_pk_mul_f32 v[2:3], v[2:3], v[84:85]
    v_pk_mul_f32 v[4:5], v[4:5], v[84:85]
    v_pk_mul_f32 v[6:7], v[6:7], v[84:85]
    v_cvt_pk_bf16_f32 v60, v0, v1
    v_cvt_pk_bf16_f32 v61, v2, v3
    v_cvt_pk_bf16_f32 v62, v4, v5
    v_cvt_pk_bf16_f32 v63, v6, v7
    s_add_u32 s53, s40, 12288
    s_waitcnt lgkmcnt(1)
    buffer_store_dwordx4 v[52:55], v117, s[20:23], s53 offen offset:384 nt
    v_accvgpr_read_b32 v120, a204
    v_accvgpr_read_b32 v121, a205
    v_permlane16_swap_b32 v60, v62
    v_permlane16_swap_b32 v61, v63
    v_accvgpr_read_b32 v122, a206
    v_accvgpr_read_b32 v123, a207
    ds_write_b128 v116, v[60:63] offset:20480
    ds_read_b128 v[48:51], v114 offset:20480
    ds_read_b128 v[52:55], v114 offset:21504
    v_accvgpr_read_b32 v124, a220
    v_accvgpr_read_b32 v125, a221
    v_accvgpr_read_b32 v126, a222
    v_accvgpr_read_b32 v127, a223
    v_pk_mul_f32 v[120:121], v[120:121], v[86:87]
    v_pk_mul_f32 v[122:123], v[122:123], v[86:87]
    v_pk_mul_f32 v[124:125], v[124:125], v[86:87]
    v_pk_mul_f32 v[126:127], v[126:127], v[86:87]
    v_cvt_pk_bf16_f32 v56, v120, v121
    v_cvt_pk_bf16_f32 v57, v122, v123
    v_cvt_pk_bf16_f32 v58, v124, v125
    v_cvt_pk_bf16_f32 v59, v126, v127
    v_accvgpr_read_b32 v0, a236
    v_accvgpr_read_b32 v1, a237
    v_permlane16_swap_b32 v56, v58
    v_permlane16_swap_b32 v57, v59
    v_accvgpr_read_b32 v2, a238
    v_accvgpr_read_b32 v3, a239
    ds_write_b128 v115, v[56:59] offset:22528
    v_accvgpr_read_b32 v4, a252
    v_accvgpr_read_b32 v5, a253
    s_add_u32 s53, s40, 16384
    s_waitcnt lgkmcnt(2)
    buffer_store_dwordx4 v[48:51], v117, s[20:23], s53 offen offset:384 nt
    v_accvgpr_read_b32 v6, a254
    v_accvgpr_read_b32 v7, a255
    v_pk_mul_f32 v[0:1], v[0:1], v[86:87]
    v_pk_mul_f32 v[2:3], v[2:3], v[86:87]
    v_pk_mul_f32 v[4:5], v[4:5], v[86:87]
    v_pk_mul_f32 v[6:7], v[6:7], v[86:87]
    v_cvt_pk_bf16_f32 v60, v0, v1
    v_cvt_pk_bf16_f32 v61, v2, v3
    v_cvt_pk_bf16_f32 v62, v4, v5
    v_cvt_pk_bf16_f32 v63, v6, v7
    s_add_u32 s53, s40, 20480
    s_waitcnt lgkmcnt(1)
    buffer_store_dwordx4 v[52:55], v117, s[20:23], s53 offen offset:384 nt
    s_nop 1
    v_permlane16_swap_b32 v60, v62
    v_permlane16_swap_b32 v61, v63
    s_nop 0
    ds_write_b128 v116, v[60:63] offset:22528
    ds_read_b128 v[48:51], v114 offset:22528
    ds_read_b128 v[52:55], v114 offset:23552
    s_add_u32 s53, s40, 24576
    s_waitcnt lgkmcnt(1)
    buffer_store_dwordx4 v[48:51], v117, s[20:23], s53 offen offset:384 nt
    s_add_u32 s53, s40, 28672
    s_waitcnt lgkmcnt(0)
    buffer_store_dwordx4 v[52:55], v117, s[20:23], s53 offen offset:384 nt
L_fe1_end:
    s_or_b64 s[6:7], s[48:49], s[4:5]
    s_cbranch_scc0 L_slow_done
    s_waitcnt vmcnt(0) lgkmcnt(0)
    s_lshl_b32 s54, s30, 12
    s_and_b32 s55, s30, 1
    s_lshl_b32 s55, s55, 7
    v_subrev_u32 v48, s54, v100
    v_xor_b32 v48, s55, v48
    v_xor_b32 v52, 128, v48
    v_subrev_u32 v56, s54, v104
    v_subrev_u32 v49, s54, v101
    v_xor_b32 v49, s55, v49
    v_xor_b32 v53, 128, v49
    v_subrev_u32 v57, s54, v105
    v_subrev_u32 v50, s54, v102
    v_xor_b32 v50, s55, v50
    v_xor_b32 v54, 128, v50
    v_subrev_u32 v58, s54, v106
    v_subrev_u32 v51, s54, v103
    v_xor_b32 v51, s55, v51
    v_xor_b32 v55, 128, v51
    v_subrev_u32 v59, s54, v107
    v_add_u32 v88, s45, v88
    v_add_u32 v89, s45, v89
    v_add_u32 v90, s45, v90
    v_add_u32 v91, s45, v91
    v_add_u32 v92, s45, v92
    v_add_u32 v93, s45, v93
    v_add_u32 v94, s45, v94
    v_add_u32 v95, s45, v95
    v_add_u32 v96, s45, v96
    v_add_u32 v97, s45, v97
    v_add_u32 v98, s45, v98
    v_add_u32 v99, s45, v99
    s_mov_b32 s47, 0
L_slow_unit:
    s_cmp_eq_u32 s47, 0
    s_cselect_b64 s[6:7], s[48:49], s[4:5]
    s_cmp_eq_u64 s[6:7], 0
    s_cbranch_scc1 L_slow_next
    s_mul_i32 s50, s47, 33554432
    s_add_u32 s39, s38, s50
    s_mul_i32 s51, s47, 16777216
    s_add_u32 s52, s39, 0
    buffer_load_dwordx4 a[0:3], v108, s[8:11], s52 offen
    buffer_load_dwordx4 a[4:7], v108, s[8:11], s52 offen offset:64
    buffer_load_dwordx4 a[8:11], v108, s[8:11], s52 offen offset:128
    buffer_load_dwordx4 a[12:15], v108, s[8:11], s52 offen offset:192
    buffer_load_dwordx4 a[16:19], v108, s[8:11], s52 offen offset:256
    buffer_load_dwordx4 a[20:23], v108, s[8:11], s52 offen offset:320
    buffer_load_dwordx4 a[24:27], v108, s[8:11], s52 offen offset:384
    buffer_load_dwordx4 a[28:31], v108, s[8:11], s52 offen offset:448
    s_add_u32 s52, s39, 8192
    buffer_load_dwordx4 a[32:35], v108, s[8:11], s52 offen
    buffer_load_dwordx4 a[36:39], v108, s[8:11], s52 offen offset:64
    buffer_load_dwordx4 a[40:43], v108, s[8:11], s52 offen offset:128
    buffer_load_dwordx4 a[44:47], v108, s[8:11], s52 offen offset:192
    buffer_load_dwordx4 a[48:51], v108, s[8:11], s52 offen offset:256
    buffer_load_dwordx4 a[52:55], v108, s[8:11], s52 offen offset:320
    buffer_load_dwordx4 a[56:59], v108, s[8:11], s52 offen offset:384
    buffer_load_dwordx4 a[60:63], v108, s[8:11], s52 offen offset:448
    s_add_u32 s52, s39, 16384
    buffer_load_dwordx4 a[64:67], v108, s[8:11], s52 offen
    buffer_load_dwordx4 a[68:71], v108, s[8:11], s52 offen offset:64
    buffer_load_dwordx4 a[72:75], v108, s[8:11], s52 offen offset:128
    buffer_load_dwordx4 a[76:79], v108, s[8:11], s52 offen offset:192
    buffer_load_dwordx4 a[80:83], v108, s[8:11], s52 offen offset:256
    buffer_load_dwordx4 a[84:87], v108, s[8:11], s52 offen offset:320
    buffer_load_dwordx4 a[88:91], v108, s[8:11], s52 offen offset:384
    buffer_load_dwordx4 a[92:95], v108, s[8:11], s52 offen offset:448
    s_add_u32 s52, s39, 24576
    buffer_load_dwordx4 a[96:99], v108, s[8:11], s52 offen
    buffer_load_dwordx4 a[100:103], v108, s[8:11], s52 offen offset:64
    buffer_load_dwordx4 a[104:107], v108, s[8:11], s52 offen offset:128
    buffer_load_dwordx4 a[108:111], v108, s[8:11], s52 offen offset:192
    buffer_load_dwordx4 a[112:115], v108, s[8:11], s52 offen offset:256
    buffer_load_dwordx4 a[116:119], v108, s[8:11], s52 offen offset:320
    buffer_load_dwordx4 a[120:123], v108, s[8:11], s52 offen offset:384
    buffer_load_dwordx4 a[124:127], v108, s[8:11], s52 offen offset:448
    v_mov_b32 v84, 0xff800000
    v_mov_b32 v85, 0xff800000
    v_mov_b32 v86, 0xff800000
    v_mov_b32 v87, 0xff800000
    s_mov_b32 s31, 0
L_slow_p1:
    s_lshl_b32 s32, s31, 14
    s_add_u32 s32, s32, s51
    s_add_u32 s52, s45, 0
    s_mov_b32 m0, s52
    s_add_u32 s53, s32, 0
    buffer_load_dwordx4 v48, s[12:15], s53 offen lds
    buffer_load_dwordx4 v49, s[12:15], s53 offen offset:1024 lds
    buffer_load_dwordx4 v50, s[12:15], s53 offen offset:2048 lds
    buffer_load_dwordx4 v51, s[12:15], s53 offen offset:3072 lds
    s_add_u32 s52, s45, 4096
    s_mov_b32 m0, s52
    s_add_u32 s53, s32, 4096
    buffer_load_dwordx4 v52, s[12:15], s53 offen lds
    buffer_load_dwordx4 v53, s[12:15], s53 offen offset:1024 lds
    buffer_load_dwordx4 v54, s[12:15], s53 offen offset:2048 lds
    buffer_load_dwordx4 v55, s[12:15], s53 offen offset:3072 lds
    s_add_u32 s52, s45, 8192
    s_mov_b32 m0, s52
    s_add_u32 s53, s32, 8192
    buffer_load_dwordx4 v48, s[12:15], s53 offen lds
    buffer_load_dwordx4 v49, s[12:15], s53 offen offset:1024 lds
    buffer_load_dwordx4 v50, s[12:15], s53 offen offset:2048 lds
    buffer_load_dwordx4 v51, s[12:15], s53 offen offset:3072 lds
    s_add_u32 s52, s45, 12288
    s_mov_b32 m0, s52
    s_add_u32 s53, s32, 12288
    buffer_load_dwordx4 v52, s[12:15], s53 offen lds
    buffer_load_dwordx4 v53, s[12:15], s53 offen offset:1024 lds
    buffer_load_dwordx4 v54, s[12:15], s53 offen offset:2048 lds
    buffer_load_dwordx4 v55, s[12:15], s53 offen offset:3072 lds
    s_waitcnt vmcnt(0) lgkmcnt(0)
    ds_read_b128 v[64:67], v88 offset:0
    s_waitcnt lgkmcnt(0)
    v_mfma_f32_16x16x32_bf16 v[0:3], v[64:67], a[0:3], 0
    v_mfma_f32_16x16x32_bf16 v[4:7], v[64:67], a[32:35], 0
    v_mfma_f32_16x16x32_bf16 v[8:11], v[64:67], a[64:67], 0
    v_mfma_f32_16x16x32_bf16 v[12:15], v[64:67], a[96:99], 0
    ds_read_b128 v[68:71], v89 offset:0
    s_waitcnt lgkmcnt(0)
    v_mfma_f32_16x16x32_bf16 v[0:3], v[68:71], a[4:7], v[0:3]
    v_mfma_f32_16x16x32_bf16 v[4:7], v[68:71], a[36:39], v[4:7]
    v_mfma_f32_16x16x32_bf16 v[8:11], v[68:71], a[68:71], v[8:11]
    v_mfma_f32_16x16x32_bf16 v[12:15], v[68:71], a[100:103], v[12:15]
    ds_read_b128 v[72:75], v90 offset:0
    s_waitcnt lgkmcnt(0)
    v_mfma_f32_16x16x32_bf16 v[0:3], v[72:75], a[8:11], v[0:3]
    v_mfma_f32_16x16x32_bf16 v[4:7], v[72:75], a[40:43], v[4:7]
    v_mfma_f32_16x16x32_bf16 v[8:11], v[72:75], a[72:75], v[8:11]
    v_mfma_f32_16x16x32_bf16 v[12:15], v[72:75], a[104:107], v[12:15]
    ds_read_b128 v[76:79], v91 offset:0
    s_waitcnt lgkmcnt(0)
    v_mfma_f32_16x16x32_bf16 v[0:3], v[76:79], a[12:15], v[0:3]
    v_mfma_f32_16x16x32_bf16 v[4:7], v[76:79], a[44:47], v[4:7]
    v_mfma_f32_16x16x32_bf16 v[8:11], v[76:79], a[76:79], v[8:11]
    v_mfma_f32_16x16x32_bf16 v[12:15], v[76:79], a[108:111], v[12:15]
    ds_read_b128 v[64:67], v88 offset:256
    s_waitcnt lgkmcnt(0)
    v_mfma_f32_16x16x32_bf16 v[0:3], v[64:67], a[16:19], v[0:3]
    v_mfma_f32_16x16x32_bf16 v[4:7], v[64:67], a[48:51], v[4:7]
    v_mfma_f32_16x16x32_bf16 v[8:11], v[64:67], a[80:83], v[8:11]
    v_mfma_f32_16x16x32_bf16 v[12:15], v[64:67], a[112:115], v[12:15]
    ds_read_b128 v[68:71], v89 offset:256
    s_waitcnt lgkmcnt(0)
    v_mfma_f32_16x16x32_bf16 v[0:3], v[68:71], a[20:23], v[0:3]
    v_mfma_f32_16x16x32_bf16 v[4:7], v[68:71], a[52:55], v[4:7]
    v_mfma_f32_16x16x32_bf16 v[8:11], v[68:71], a[84:87], v[8:11]
    v_mfma_f32_16x16x32_bf16 v[12:15], v[68:71], a[116:119], v[12:15]
    ds_read_b128 v[72:75], v90 offset:256
    s_waitcnt lgkmcnt(0)
    v_mfma_f32_16x16x32_bf16 v[0:3], v[72:75], a[24:27], v[0:3]
    v_mfma_f32_16x16x32_bf16 v[4:7], v[72:75], a[56:59], v[4:7]
    v_mfma_f32_16x16x32_bf16 v[8:11], v[72:75], a[88:91], v[8:11]
    v_mfma_f32_16x16x32_bf16 v[12:15], v[72:75], a[120:123], v[12:15]
    ds_read_b128 v[76:79], v91 offset:256
    s_waitcnt lgkmcnt(0)
    v_mfma_f32_16x16x32_bf16 v[0:3], v[76:79], a[28:31], v[0:3]
    v_mfma_f32_16x16x32_bf16 v[4:7], v[76:79], a[60:63], v[4:7]
    v_mfma_f32_16x16x32_bf16 v[8:11], v[76:79], a[92:95], v[8:11]
    v_mfma_f32_16x16x32_bf16 v[12:15], v[76:79], a[124:127], v[12:15]
    ds_read_b128 v[64:67], v88 offset:8192
    s_waitcnt lgkmcnt(0)
    v_mfma_f32_16x16x32_bf16 v[16:19], v[64:67], a[0:3], 0
    v_mfma_f32_16x16x32_bf16 v[20:23], v[64:67], a[32:35], 0
    v_mfma_f32_16x16x32_bf16 v[24:27], v[64:67], a[64:67], 0
    v_mfma_f32_16x16x32_bf16 v[28:31], v[64:67], a[96:99], 0
    ds_read_b128 v[68:71], v89 offset:8192
    s_waitcnt lgkmcnt(0)
    v_mfma_f32_16x16x32_bf16 v[16:19], v[68:71], a[4:7], v[16:19]
    v_mfma_f32_16x16x32_bf16 v[20:23], v[68:71], a[36:39], v[20:23]
    v_mfma_f32_16x16x32_bf16 v[24:27], v[68:71], a[68:71], v[24:27]
    v_mfma_f32_16x16x32_bf16 v[28:31], v[68:71], a[100:103], v[28:31]
    ds_read_b128 v[72:75], v90 offset:8192
    s_waitcnt lgkmcnt(0)
    v_mfma_f32_16x16x32_bf16 v[16:19], v[72:75], a[8:11], v[16:19]
    v_mfma_f32_16x16x32_bf16 v[20:23], v[72:75], a[40:43], v[20:23]
    v_mfma_f32_16x16x32_bf16 v[24:27], v[72:75], a[72:75], v[24:27]
    v_mfma_f32_16x16x32_bf16 v[28:31], v[72:75], a[104:107], v[28:31]
    ds_read_b128 v[76:79], v91 offset:8192
    s_waitcnt lgkmcnt(0)
    v_mfma_f32_16x16x32_bf16 v[16:19], v[76:79], a[12:15], v[16:19]
    v_mfma_f32_16x16x32_bf16 v[20:23], v[76:79], a[44:47], v[20:23]
    v_mfma_f32_16x16x32_bf16 v[24:27], v[76:79], a[76:79], v[24:27]
    v_mfma_f32_16x16x32_bf16 v[28:31], v[76:79], a[108:111], v[28:31]
    ds_read_b128 v[64:67], v88 offset:8448
    s_waitcnt lgkmcnt(0)
    v_mfma_f32_16x16x32_bf16 v[16:19], v[64:67], a[16:19], v[16:19]
    v_mfma_f32_16x16x32_bf16 v[20:23], v[64:67], a[48:51], v[20:23]
    v_mfma_f32_16x16x32_bf16 v[24:27], v[64:67], a[80:83], v[24:27]
    v_mfma_f32_16x16x32_bf16 v[28:31], v[64:67], a[112:115], v[28:31]
    ds_read_b128 v[68:71], v89 offset:8448
    s_waitcnt lgkmcnt(0)
    v_mfma_f32_16x16x32_bf16 v[16:19], v[68:71], a[20:23], v[16:19]
    v_mfma_f32_16x16x32_bf16 v[20:23], v[68:71], a[52:55], v[20:23]
    v_mfma_f32_16x16x32_bf16 v[24:27], v[68:71], a[84:87], v[24:27]
    v_mfma_f32_16x16x32_bf16 v[28:31], v[68:71], a[116:119], v[28:31]
    ds_read_b128 v[72:75], v90 offset:8448
    s_waitcnt lgkmcnt(0)
    v_mfma_f32_16x16x32_bf16 v[16:19], v[72:75], a[24:27], v[16:19]
    v_mfma_f32_16x16x32_bf16 v[20:23], v[72:75], a[56:59], v[20:23]
    v_mfma_f32_16x16x32_bf16 v[24:27], v[72:75], a[88:91], v[24:27]
    v_mfma_f32_16x16x32_bf16 v[28:31], v[72:75], a[120:123], v[28:31]
    ds_read_b128 v[76:79], v91 offset:8448
    s_waitcnt lgkmcnt(0)
    v_mfma_f32_16x16x32_bf16 v[16:19], v[76:79], a[28:31], v[16:19]
    v_mfma_f32_16x16x32_bf16 v[20:23], v[76:79], a[60:63], v[20:23]
    v_mfma_f32_16x16x32_bf16 v[24:27], v[76:79], a[92:95], v[24:27]
    v_mfma_f32_16x16x32_bf16 v[28:31], v[76:79], a[124:127], v[28:31]
    s_nop 7
    s_nop 1
    v_max3_f32 v84, v84, v0, v1
    v_max3_f32 v84, v84, v2, v3
    v_max3_f32 v84, v84, v16, v17
    v_max3_f32 v84, v84, v18, v19
    v_max3_f32 v85, v85, v4, v5
    v_max3_f32 v85, v85, v6, v7
    v_max3_f32 v85, v85, v20, v21
    v_max3_f32 v85, v85, v22, v23
    v_max3_f32 v86, v86, v8, v9
    v_max3_f32 v86, v86, v10, v11
    v_max3_f32 v86, v86, v24, v25
    v_max3_f32 v86, v86, v26, v27
    v_max3_f32 v87, v87, v12, v13
    v_max3_f32 v87, v87, v14, v15
    v_max3_f32 v87, v87, v28, v29
    v_max3_f32 v87, v87, v30, v31
    s_add_u32 s31, s31, 1
    s_cmp_lt_u32 s31, 16
    s_cbranch_scc1 L_slow_p1
    v_mov_b32 v120, v84
    v_mov_b32 v121, v85
    v_mov_b32 v122, v86
    v_mov_b32 v123, v87
    s_nop 1
    v_permlane16_swap_b32 v84, v120
    v_permlane16_swap_b32 v85, v121
    v_permlane16_swap_b32 v86, v122
    v_permlane16_swap_b32 v87, v123
    s_nop 1
    v_max_f32 v84, v84, v120
    v_max_f32 v85, v85, v121
    v_max_f32 v86, v86, v122
    v_max_f32 v87, v87, v123
    v_mov_b32 v120, v84
    v_mov_b32 v121, v85
    v_mov_b32 v122, v86
    v_mov_b32 v123, v87
    s_nop 1
    v_permlane32_swap_b32 v84, v120
    v_permlane32_swap_b32 v85, v121
    v_permlane32_swap_b32 v86, v122
    v_permlane32_swap_b32 v87, v123
    s_nop 1
    v_max_f32 v84, v84, v120
    v_max_f32 v85, v85, v121
    v_max_f32 v86, v86, v122
    v_max_f32 v87, v87, v123
    v_mul_f32 v84, s28, v84
    v_mul_f32 v85, s28, v85
    v_mul_f32 v86, s28, v86
    v_mul_f32 v87, s28, v87
    v_mov_b32 v80, 0
    v_mov_b32 v81, 0
    v_mov_b32 v82, 0
    v_mov_b32 v83, 0
    v_mov_b32 v128, 0
    v_mov_b32 v129, 0
    v_mov_b32 v130, 0
    v_mov_b32 v131, 0
    v_mov_b32 v132, 0
    v_mov_b32 v133, 0
    v_mov_b32 v134, 0
    v_mov_b32 v135, 0
    v_mov_b32 v136, 0
    v_mov_b32 v137, 0
    v_mov_b32 v138, 0
    v_mov_b32 v139, 0
    v_mov_b32 v140, 0
    v_mov_b32 v141, 0
    v_mov_b32 v142, 0
    v_mov_b32 v143, 0
    v_mov_b32 v144, 0
    v_mov_b32 v145, 0
    v_mov_b32 v146, 0
    v_mov_b32 v147, 0
    v_mov_b32 v148, 0
    v_mov_b32 v149, 0
    v_mov_b32 v150, 0
    v_mov_b32 v151, 0
    v_mov_b32 v152, 0
    v_mov_b32 v153, 0
    v_mov_b32 v154, 0
    v_mov_b32 v155, 0
    v_mov_b32 v156, 0
    v_mov_b32 v157, 0
    v_mov_b32 v158, 0
    v_mov_b32 v159, 0
    v_mov_b32 v160, 0
    v_mov_b32 v161, 0
    v_mov_b32 v162, 0
    v_mov_b32 v163, 0
    v_mov_b32 v164, 0
    v_mov_b32 v165, 0
    v_mov_b32 v166, 0
    v_mov_b32 v167, 0
    v_mov_b32 v168, 0
    v_mov_b32 v169, 0
    v_mov_b32 v170, 0
    v_mov_b32 v171, 0
    v_mov_b32 v172, 0
    v_mov_b32 v173, 0
    v_mov_b32 v174, 0
    v_mov_b32 v175, 0
    v_mov_b32 v176, 0
    v_mov_b32 v177, 0
    v_mov_b32 v178, 0
    v_mov_b32 v179, 0
    v_mov_b32 v180, 0
    v_mov_b32 v181, 0
    v_mov_b32 v182, 0
    v_mov_b32 v183, 0
    v_mov_b32 v184, 0
    v_mov_b32 v185, 0
    v_mov_b32 v186, 0
    v_mov_b32 v187, 0
    v_mov_b32 v188, 0
    v_mov_b32 v189, 0
    v_mov_b32 v190, 0
    v_mov_b32 v191, 0
    v_mov_b32 v192, 0
    v_mov_b32 v193, 0
    v_mov_b32 v194, 0
    v_mov_b32 v195, 0
    v_mov_b32 v196, 0
    v_mov_b32 v197, 0
    v_mov_b32 v198, 0
    v_mov_b32 v199, 0
    v_mov_b32 v200, 0
    v_mov_b32 v201, 0
    v_mov_b32 v202, 0
    v_mov_b32 v203, 0
    v_mov_b32 v204, 0
    v_mov_b32 v205, 0
    v_mov_b32 v206, 0
    v_mov_b32 v207, 0
    v_mov_b32 v208, 0
    v_mov_b32 v209, 0
    v_mov_b32 v210, 0
    v_mov_b32 v211, 0
    v_mov_b32 v212, 0
    v_mov_b32 v213, 0
    v_mov_b32 v214, 0
    v_mov_b32 v215, 0
    v_mov_b32 v216, 0
    v_mov_b32 v217, 0
    v_mov_b32 v218, 0
    v_mov_b32 v219, 0
    v_mov_b32 v220, 0
    v_mov_b32 v221, 0
    v_mov_b32 v222, 0
    v_mov_b32 v223, 0
    v_mov_b32 v224, 0
    v_mov_b32 v225, 0
    v_mov_b32 v226, 0
    v_mov_b32 v227, 0
    v_mov_b32 v228, 0
    v_mov_b32 v229, 0
    v_mov_b32 v230, 0
    v_mov_b32 v231, 0
    v_mov_b32 v232, 0
    v_mov_b32 v233, 0
    v_mov_b32 v234, 0
    v_mov_b32 v235, 0
    v_mov_b32 v236, 0
    v_mov_b32 v237, 0
    v_mov_b32 v238, 0
    v_mov_b32 v239, 0
    v_mov_b32 v240, 0
    v_mov_b32 v241, 0
    v_mov_b32 v242, 0
    v_mov_b32 v243, 0
    v_mov_b32 v244, 0
    v_mov_b32 v245, 0
    v_mov_b32 v246, 0
    v_mov_b32 v247, 0
    v_mov_b32 v248, 0
    v_mov_b32 v249, 0
    v_mov_b32 v250, 0
    v_mov_b32 v251, 0
    v_mov_b32 v252, 0
    v_mov_b32 v253, 0
    v_mov_b32 v254, 0
    v_mov_b32 v255, 0
    v_accvgpr_write_b32 a128, 0
    v_accvgpr_write_b32 a129, 0
    v_accvgpr_write_b32 a130, 0
    v_accvgpr_write_b32 a131, 0
    v_accvgpr_write_b32 a132, 0
    v_accvgpr_write_b32 a133, 0
    v_accvgpr_write_b32 a134, 0
    v_accvgpr_write_b32 a135, 0
    v_accvgpr_write_b32 a136, 0
    v_accvgpr_write_b32 a137, 0
    v_accvgpr_write_b32 a138, 0
    v_accvgpr_write_b32 a139, 0
    v_accvgpr_write_b32 a140, 0
    v_accvgpr_write_b32 a141, 0
    v_accvgpr_write_b32 a142, 0
    v_accvgpr_write_b32 a143, 0
    v_accvgpr_write_b32 a144, 0
    v_accvgpr_write_b32 a145, 0
    v_accvgpr_write_b32 a146, 0
    v_accvgpr_write_b32 a147, 0
    v_accvgpr_write_b32 a148, 0
    v_accvgpr_write_b32 a149, 0
    v_accvgpr_write_b32 a150, 0
    v_accvgpr_write_b32 a151, 0
    v_accvgpr_write_b32 a152, 0
    v_accvgpr_write_b32 a153, 0
    v_accvgpr_write_b32 a154, 0
    v_accvgpr_write_b32 a155, 0
    v_accvgpr_write_b32 a156, 0
    v_accvgpr_write_b32 a157, 0
    v_accvgpr_write_b32 a158, 0
    v_accvgpr_write_b32 a159, 0
    v_accvgpr_write_b32 a160, 0
    v_accvgpr_write_b32 a161, 0
    v_accvgpr_write_b32 a162, 0
    v_accvgpr_write_b32 a163, 0
    v_accvgpr_write_b32 a164, 0
    v_accvgpr_write_b32 a165, 0
    v_accvgpr_write_b32 a166, 0
    v_accvgpr_write_b32 a167, 0
    v_accvgpr_write_b32 a168, 0
    v_accvgpr_write_b32 a169, 0
    v_accvgpr_write_b32 a170, 0
    v_accvgpr_write_b32 a171, 0
    v_accvgpr_write_b32 a172, 0
    v_accvgpr_write_b32 a173, 0
    v_accvgpr_write_b32 a174, 0
    v_accvgpr_write_b32 a175, 0
    v_accvgpr_write_b32 a176, 0
    v_accvgpr_write_b32 a177, 0
    v_accvgpr_write_b32 a178, 0
    v_accvgpr_write_b32 a179, 0
    v_accvgpr_write_b32 a180, 0
    v_accvgpr_write_b32 a181, 0
    v_accvgpr_write_b32 a182, 0
    v_accvgpr_write_b32 a183, 0
    v_accvgpr_write_b32 a184, 0
    v_accvgpr_write_b32 a185, 0
    v_accvgpr_write_b32 a186, 0
    v_accvgpr_write_b32 a187, 0
    v_accvgpr_write_b32 a188, 0
    v_accvgpr_write_b32 a189, 0
    v_accvgpr_write_b32 a190, 0
    v_accvgpr_write_b32 a191, 0
    v_accvgpr_write_b32 a192, 0
    v_accvgpr_write_b32 a193, 0
    v_accvgpr_write_b32 a194, 0
    v_accvgpr_write_b32 a195, 0
    v_accvgpr_write_b32 a196, 0
    v_accvgpr_write_b32 a197, 0
    v_accvgpr_write_b32 a198, 0
    v_accvgpr_write_b32 a199, 0
    v_accvgpr_write_b32 a200, 0
    v_accvgpr_write_b32 a201, 0
    v_accvgpr_write_b32 a202, 0
    v_accvgpr_write_b32 a203, 0
    v_accvgpr_write_b32 a204, 0
    v_accvgpr_write_b32 a205, 0
    v_accvgpr_write_b32 a206, 0
    v_accvgpr_write_b32 a207, 0
    v_accvgpr_write_b32 a208, 0
    v_accvgpr_write_b32 a209, 0
    v_accvgpr_write_b32 a210, 0
    v_accvgpr_write_b32 a211, 0
    v_accvgpr_write_b32 a212, 0
    v_accvgpr_write_b32 a213, 0
    v_accvgpr_write_b32 a214, 0
    v_accvgpr_write_b32 a215, 0
    v_accvgpr_write_b32 a216, 0
    v_accvgpr_write_b32 a217, 0
    v_accvgpr_write_b32 a218, 0
    v_accvgpr_write_b32 a219, 0
    v_accvgpr_write_b32 a220, 0
    v_accvgpr_write_b32 a221, 0
    v_accvgpr_write_b32 a222, 0
    v_accvgpr_write_b32 a223, 0
    v_accvgpr_write_b32 a224, 0
    v_accvgpr_write_b32 a225, 0
    v_accvgpr_write_b32 a226, 0
    v_accvgpr_write_b32 a227, 0
    v_accvgpr_write_b32 a228, 0
    v_accvgpr_write_b32 a229, 0
    v_accvgpr_write_b32 a230, 0
    v_accvgpr_write_b32 a231, 0
    v_accvgpr_write_b32 a232, 0
    v_accvgpr_write_b32 a233, 0
    v_accvgpr_write_b32 a234, 0
    v_accvgpr_write_b32 a235, 0
    v_accvgpr_write_b32 a236, 0
    v_accvgpr_write_b32 a237, 0
    v_accvgpr_write_b32 a238, 0
    v_accvgpr_write_b32 a239, 0
    v_accvgpr_write_b32 a240, 0
    v_accvgpr_write_b32 a241, 0
    v_accvgpr_write_b32 a242, 0
    v_accvgpr_write_b32 a243, 0
    v_accvgpr_write_b32 a244, 0
    v_accvgpr_write_b32 a245, 0
    v_accvgpr_write_b32 a246, 0
    v_accvgpr_write_b32 a247, 0
    v_accvgpr_write_b32 a248, 0
    v_accvgpr_write_b32 a249, 0
    v_accvgpr_write_b32 a250, 0
    v_accvgpr_write_b32 a251, 0
    v_accvgpr_write_b32 a252, 0
    v_accvgpr_write_b32 a253, 0
    v_accvgpr_write_b32 a254, 0
    v_accvgpr_write_b32 a255, 0
    s_mov_b32 s31, 0
L_slow_p2:
    s_lshl_b32 s32, s31, 14
    s_add_u32 s32, s32, s51
    s_add_u32 s52, s45, 0
    s_mov_b32 m0, s52
    s_add_u32 s53, s32, 0
    buffer_load_dwordx4 v48, s[12:15], s53 offen lds
    buffer_load_dwordx4 v49, s[12:15], s53 offen offset:1024 lds
    buffer_load_dwordx4 v50, s[12:15], s53 offen offset:2048 lds
    buffer_load_dwordx4 v51, s[12:15], s53 offen offset:3072 lds
    s_add_u32 s52, s45, 4096
    s_mov_b32 m0, s52
    s_add_u32 s53, s32, 4096
    buffer_load_dwordx4 v52, s[12:15], s53 offen lds
    buffer_load_dwordx4 v53, s[12:15], s53 offen offset:1024 lds
    buffer_load_dwordx4 v54, s[12:15], s53 offen offset:2048 lds
    buffer_load_dwordx4 v55, s[12:15], s53 offen offset:3072 lds
    s_add_u32 s52, s45, 8192
    s_mov_b32 m0, s52
    s_add_u32 s53, s32, 8192
    buffer_load_dwordx4 v48, s[12:15], s53 offen lds
    buffer_load_dwordx4 v49, s[12:15], s53 offen offset:1024 lds
    buffer_load_dwordx4 v50, s[12:15], s53 offen offset:2048 lds
    buffer_load_dwordx4 v51, s[12:15], s53 offen offset:3072 lds
    s_add_u32 s52, s45, 12288
    s_mov_b32 m0, s52
    s_add_u32 s53, s32, 12288
    buffer_load_dwordx4 v52, s[12:15], s53 offen lds
    buffer_load_dwordx4 v53, s[12:15], s53 offen offset:1024 lds
    buffer_load_dwordx4 v54, s[12:15], s53 offen offset:2048 lds
    buffer_load_dwordx4 v55, s[12:15], s53 offen offset:3072 lds
    s_waitcnt vmcnt(0) lgkmcnt(0)
    ds_read_b128 v[64:67], v88 offset:0
    s_waitcnt lgkmcnt(0)
    v_mfma_f32_16x16x32_bf16 v[0:3], v[64:67], a[0:3], 0
    v_mfma_f32_16x16x32_bf16 v[4:7], v[64:67], a[32:35], 0
    v_mfma_f32_16x16x32_bf16 v[8:11], v[64:67], a[64:67], 0
    v_mfma_f32_16x16x32_bf16 v[12:15], v[64:67], a[96:99], 0
    ds_read_b128 v[68:71], v89 offset:0
    s_waitcnt lgkmcnt(0)
    v_mfma_f32_16x16x32_bf16 v[0:3], v[68:71], a[4:7], v[0:3]
    v_mfma_f32_16x16x32_bf16 v[4:7], v[68:71], a[36:39], v[4:7]
    v_mfma_f32_16x16x32_bf16 v[8:11], v[68:71], a[68:71], v[8:11]
    v_mfma_f32_16x16x32_bf16 v[12:15], v[68:71], a[100:103], v[12:15]
    ds_read_b128 v[72:75], v90 offset:0
    s_waitcnt lgkmcnt(0)
    v_mfma_f32_16x16x32_bf16 v[0:3], v[72:75], a[8:11], v[0:3]
    v_mfma_f32_16x16x32_bf16 v[4:7], v[72:75], a[40:43], v[4:7]
    v_mfma_f32_16x16x32_bf16 v[8:11], v[72:75], a[72:75], v[8:11]
    v_mfma_f32_16x16x32_bf16 v[12:15], v[72:75], a[104:107], v[12:15]
    ds_read_b128 v[76:79], v91 offset:0
    s_waitcnt lgkmcnt(0)
    v_mfma_f32_16x16x32_bf16 v[0:3], v[76:79], a[12:15], v[0:3]
    v_mfma_f32_16x16x32_bf16 v[4:7], v[76:79], a[44:47], v[4:7]
    v_mfma_f32_16x16x32_bf16 v[8:11], v[76:79], a[76:79], v[8:11]
    v_mfma_f32_16x16x32_bf16 v[12:15], v[76:79], a[108:111], v[12:15]
    ds_read_b128 v[64:67], v88 offset:256
    s_waitcnt lgkmcnt(0)
    v_mfma_f32_16x16x32_bf16 v[0:3], v[64:67], a[16:19], v[0:3]
    v_mfma_f32_16x16x32_bf16 v[4:7], v[64:67], a[48:51], v[4:7]
    v_mfma_f32_16x16x32_bf16 v[8:11], v[64:67], a[80:83], v[8:11]
    v_mfma_f32_16x16x32_bf16 v[12:15], v[64:67], a[112:115], v[12:15]
    ds_read_b128 v[68:71], v89 offset:256
    s_waitcnt lgkmcnt(0)
    v_mfma_f32_16x16x32_bf16 v[0:3], v[68:71], a[20:23], v[0:3]
    v_mfma_f32_16x16x32_bf16 v[4:7], v[68:71], a[52:55], v[4:7]
    v_mfma_f32_16x16x32_bf16 v[8:11], v[68:71], a[84:87], v[8:11]
    v_mfma_f32_16x16x32_bf16 v[12:15], v[68:71], a[116:119], v[12:15]
    ds_read_b128 v[72:75], v90 offset:256
    s_waitcnt lgkmcnt(0)
    v_mfma_f32_16x16x32_bf16 v[0:3], v[72:75], a[24:27], v[0:3]
    v_mfma_f32_16x16x32_bf16 v[4:7], v[72:75], a[56:59], v[4:7]
    v_mfma_f32_16x16x32_bf16 v[8:11], v[72:75], a[88:91], v[8:11]
    v_mfma_f32_16x16x32_bf16 v[12:15], v[72:75], a[120:123], v[12:15]
    ds_read_b128 v[76:79], v91 offset:256
    s_waitcnt lgkmcnt(0)
    v_mfma_f32_16x16x32_bf16 v[0:3], v[76:79], a[28:31], v[0:3]
    v_mfma_f32_16x16x32_bf16 v[4:7], v[76:79], a[60:63], v[4:7]
    v_mfma_f32_16x16x32_bf16 v[8:11], v[76:79], a[92:95], v[8:11]
    v_mfma_f32_16x16x32_bf16 v[12:15], v[76:79], a[124:127], v[12:15]
    ds_read_b128 v[64:67], v88 offset:8192
    s_waitcnt lgkmcnt(0)
    v_mfma_f32_16x16x32_bf16 v[16:19], v[64:67], a[0:3], 0
    v_mfma_f32_16x16x32_bf16 v[20:23], v[64:67], a[32:35], 0
    v_mfma_f32_16x16x32_bf16 v[24:27], v[64:67], a[64:67], 0
    v_mfma_f32_16x16x32_bf16 v[28:31], v[64:67], a[96:99], 0
    ds_read_b128 v[68:71], v89 offset:8192
    s_waitcnt lgkmcnt(0)
    v_mfma_f32_16x16x32_bf16 v[16:19], v[68:71], a[4:7], v[16:19]
    v_mfma_f32_16x16x32_bf16 v[20:23], v[68:71], a[36:39], v[20:23]
    v_mfma_f32_16x16x32_bf16 v[24:27], v[68:71], a[68:71], v[24:27]
    v_mfma_f32_16x16x32_bf16 v[28:31], v[68:71], a[100:103], v[28:31]
    ds_read_b128 v[72:75], v90 offset:8192
    s_waitcnt lgkmcnt(0)
    v_mfma_f32_16x16x32_bf16 v[16:19], v[72:75], a[8:11], v[16:19]
    v_mfma_f32_16x16x32_bf16 v[20:23], v[72:75], a[40:43], v[20:23]
    v_mfma_f32_16x16x32_bf16 v[24:27], v[72:75], a[72:75], v[24:27]
    v_mfma_f32_16x16x32_bf16 v[28:31], v[72:75], a[104:107], v[28:31]
    ds_read_b128 v[76:79], v91 offset:8192
    s_waitcnt lgkmcnt(0)
    v_mfma_f32_16x16x32_bf16 v[16:19], v[76:79], a[12:15], v[16:19]
    v_mfma_f32_16x16x32_bf16 v[20:23], v[76:79], a[44:47], v[20:23]
    v_mfma_f32_16x16x32_bf16 v[24:27], v[76:79], a[76:79], v[24:27]
    v_mfma_f32_16x16x32_bf16 v[28:31], v[76:79], a[108:111], v[28:31]
    ds_read_b128 v[64:67], v88 offset:8448
    s_waitcnt lgkmcnt(0)
    v_mfma_f32_16x16x32_bf16 v[16:19], v[64:67], a[16:19], v[16:19]
    v_mfma_f32_16x16x32_bf16 v[20:23], v[64:67], a[48:51], v[20:23]
    v_mfma_f32_16x16x32_bf16 v[24:27], v[64:67], a[80:83], v[24:27]
    v_mfma_f32_16x16x32_bf16 v[28:31], v[64:67], a[112:115], v[28:31]
    ds_read_b128 v[68:71], v89 offset:8448
    s_waitcnt lgkmcnt(0)
    v_mfma_f32_16x16x32_bf16 v[16:19], v[68:71], a[20:23], v[16:19]
    v_mfma_f32_16x16x32_bf16 v[20:23], v[68:71], a[52:55], v[20:23]
    v_mfma_f32_16x16x32_bf16 v[24:27], v[68:71], a[84:87], v[24:27]
    v_mfma_f32_16x16x32_bf16 v[28:31], v[68:71], a[116:119], v[28:31]
    ds_read_b128 v[72:75], v90 offset:8448
    s_waitcnt lgkmcnt(0)
    v_mfma_f32_16x16x32_bf16 v[16:19], v[72:75], a[24:27], v[16:19]
    v_mfma_f32_16x16x32_bf16 v[20:23], v[72:75], a[56:59], v[20:23]
    v_mfma_f32_16x16x32_bf16 v[24:27], v[72:75], a[88:91], v[24:27]
    v_mfma_f32_16x16x32_bf16 v[28:31], v[72:75], a[120:123], v[28:31]
    ds_read_b128 v[76:79], v91 offset:8448
    s_waitcnt lgkmcnt(0)
    v_mfma_f32_16x16x32_bf16 v[16:19], v[76:79], a[28:31], v[16:19]
    v_mfma_f32_16x16x32_bf16 v[20:23], v[76:79], a[60:63], v[20:23]
    v_mfma_f32_16x16x32_bf16 v[24:27], v[76:79], a[92:95], v[24:27]
    v_mfma_f32_16x16x32_bf16 v[28:31], v[76:79], a[124:127], v[28:31]
    s_nop 7
    s_nop 1
    v_fma_f32 v0, v0, s28, -v84
    v_fma_f32 v1, v1, s28, -v84
    v_fma_f32 v2, v2, s28, -v84
    v_fma_f32 v3, v3, s28, -v84
    v_exp_f32 v0, v0
    v_exp_f32 v1, v1
    v_exp_f32 v2, v2
    v_exp_f32 v3, v3
    s_nop 0
    v_add_f32 v80, v80, v0
    v_add_f32 v80, v80, v1
    v_add_f32 v80, v80, v2
    v_add_f32 v80, v80, v3
    v_cvt_pk_bf16_f32 v32, v0, v1
    v_cvt_pk_bf16_f32 v33, v2, v3
    v_fma_f32 v4, v4, s28, -v85
    v_fma_f32 v5, v5, s28, -v85
    v_fma_f32 v6, v6, s28, -v85
    v_fma_f32 v7, v7, s28, -v85
    v_exp_f32 v4, v4
    v_exp_f32 v5, v5
    v_exp_f32 v6, v6
    v_exp_f32 v7, v7
    s_nop 0
    v_add_f32 v81, v81, v4
    v_add_f32 v81, v81, v5
    v_add_f32 v81, v81, v6
    v_add_f32 v81, v81, v7
    v_cvt_pk_bf16_f32 v36, v4, v5
    v_cvt_pk_bf16_f32 v37, v6, v7
    v_fma_f32 v8, v8, s28, -v86
    v_fma_f32 v9, v9, s28, -v86
    v_fma_f32 v10, v10, s28, -v86
    v_fma_f32 v11, v11, s28, -v86
    v_exp_f32 v8, v8
    v_exp_f32 v9, v9
    v_exp_f32 v10, v10
    v_exp_f32 v11, v11
    s_nop 0
    v_add_f32 v82, v82, v8
    v_add_f32 v82, v82, v9
    v_add_f32 v82, v82, v10
    v_add_f32 v82, v82, v11
    v_cvt_pk_bf16_f32 v40, v8, v9
    v_cvt_pk_bf16_f32 v41, v10, v11
    v_fma_f32 v12, v12, s28, -v87
    v_fma_f32 v13, v13, s28, -v87
    v_fma_f32 v14, v14, s28, -v87
    v_fma_f32 v15, v15, s28, -v87
    v_exp_f32 v12, v12
    v_exp_f32 v13, v13
    v_exp_f32 v14, v14
    v_exp_f32 v15, v15
    s_nop 0
    v_add_f32 v83, v83, v12
    v_add_f32 v83, v83, v13
    v_add_f32 v83, v83, v14
    v_add_f32 v83, v83, v15
    v_cvt_pk_bf16_f32 v44, v12, v13
    v_cvt_pk_bf16_f32 v45, v14, v15
    v_fma_f32 v16, v16, s28, -v84
    v_fma_f32 v17, v17, s28, -v84
    v_fma_f32 v18, v18, s28, -v84
    v_fma_f32 v19, v19, s28, -v84
    v_exp_f32 v16, v16
    v_exp_f32 v17, v17
    v_exp_f32 v18, v18
    v_exp_f32 v19, v19
    s_nop 0
    v_add_f32 v80, v80, v16
    v_add_f32 v80, v80, v17
    v_add_f32 v80, v80, v18
    v_add_f32 v80, v80, v19
    v_cvt_pk_bf16_f32 v34, v16, v17
    v_cvt_pk_bf16_f32 v35, v18, v19
    v_fma_f32 v20, v20, s28, -v85
    v_fma_f32 v21, v21, s28, -v85
    v_fma_f32 v22, v22, s28, -v85
    v_fma_f32 v23, v23, s28, -v85
    v_exp_f32 v20, v20
    v_exp_f32 v21, v21
    v_exp_f32 v22, v22
    v_exp_f32 v23, v23
    s_nop 0
    v_add_f32 v81, v81, v20
    v_add_f32 v81, v81, v21
    v_add_f32 v81, v81, v22
    v_add_f32 v81, v81, v23
    v_cvt_pk_bf16_f32 v38, v20, v21
    v_cvt_pk_bf16_f32 v39, v22, v23
    v_fma_f32 v24, v24, s28, -v86
    v_fma_f32 v25, v25, s28, -v86
    v_fma_f32 v26, v26, s28, -v86
    v_fma_f32 v27, v27, s28, -v86
    v_exp_f32 v24, v24
    v_exp_f32 v25, v25
    v_exp_f32 v26, v26
    v_exp_f32 v27, v27
    s_nop 0
    v_add_f32 v82, v82, v24
    v_add_f32 v82, v82, v25
    v_add_f32 v82, v82, v26
    v_add_f32 v82, v82, v27
    v_cvt_pk_bf16_f32 v42, v24, v25
    v_cvt_pk_bf16_f32 v43, v26, v27
    v_fma_f32 v28, v28, s28, -v87
    v_fma_f32 v29, v29, s28, -v87
    v_fma_f32 v30, v30, s28, -v87
    v_fma_f32 v31, v31, s28, -v87
    v_exp_f32 v28, v28
    v_exp_f32 v29, v29
    v_exp_f32 v30, v30
    v_exp_f32 v31, v31
    s_nop 0
    v_add_f32 v83, v83, v28
    v_add_f32 v83, v83, v29
    v_add_f32 v83, v83, v30
    v_add_f32 v83, v83, v31
    v_cvt_pk_bf16_f32 v46, v28, v29
    v_cvt_pk_bf16_f32 v47, v30, v31
    s_add_u32 s52, s45, 0
    s_mov_b32 m0, s52
    s_add_u32 s53, s32, 0
    buffer_load_dwordx4 v56, s[16:19], s53 offen lds
    buffer_load_dwordx4 v57, s[16:19], s53 offen offset:1024 lds
    buffer_load_dwordx4 v58, s[16:19], s53 offen offset:2048 lds
    buffer_load_dwordx4 v59, s[16:19], s53 offen offset:3072 lds
    s_add_u32 s52, s45, 4096
    s_mov_b32 m0, s52
    s_add_u32 s53, s32, 4096
    buffer_load_dwordx4 v56, s[16:19], s53 offen lds
    buffer_load_dwordx4 v57, s[16:19], s53 offen offset:1024 lds
    buffer_load_dwordx4 v58, s[16:19], s53 offen offset:2048 lds
    buffer_load_dwordx4 v59, s[16:19], s53 offen offset:3072 lds
    s_add_u32 s52, s45, 8192
    s_mov_b32 m0, s52
    s_add_u32 s53, s32, 8192
    buffer_load_dwordx4 v56, s[16:19], s53 offen lds
    buffer_load_dwordx4 v57, s[16:19], s53 offen offset:1024 lds
    buffer_load_dwordx4 v58, s[16:19], s53 offen offset:2048 lds
    buffer_load_dwordx4 v59, s[16:19], s53 offen offset:3072 lds
    s_add_u32 s52, s45, 12288
    s_mov_b32 m0, s52
    s_add_u32 s53, s32, 12288
    buffer_load_dwordx4 v56, s[16:19], s53 offen lds
    buffer_load_dwordx4 v57, s[16:19], s53 offen offset:1024 lds
    buffer_load_dwordx4 v58, s[16:19], s53 offen offset:2048 lds
    buffer_load_dwordx4 v59, s[16:19], s53 offen offset:3072 lds
    s_waitcnt vmcnt(0) lgkmcnt(0)
    ds_read_b64_tr_b16 v[64:65], v92 offset:0
    ds_read_b64_tr_b16 v[66:67], v92 offset:8192
    s_waitcnt lgkmcnt(0)
    v_mfma_f32_16x16x32_bf16 v[128:131], v[64:67], v[32:35], v[128:131]
    v_mfma_f32_16x16x32_bf16 v[132:135], v[64:67], v[36:39], v[132:135]
    v_mfma_f32_16x16x32_bf16 v[136:139], v[64:67], v[40:43], v[136:139]
    v_mfma_f32_16x16x32_bf16 v[140:143], v[64:67], v[44:47], v[140:143]
    ds_read_b64_tr_b16 v[68:69], v93 offset:0
    ds_read_b64_tr_b16 v[70:71], v93 offset:8192
    s_waitcnt lgkmcnt(0)
    v_mfma_f32_16x16x32_bf16 v[144:147], v[68:71], v[32:35], v[144:147]
    v_mfma_f32_16x16x32_bf16 v[148:151], v[68:71], v[36:39], v[148:151]
    v_mfma_f32_16x16x32_bf16 v[152:155], v[68:71], v[40:43], v[152:155]
    v_mfma_f32_16x16x32_bf16 v[156:159], v[68:71], v[44:47], v[156:159]
    ds_read_b64_tr_b16 v[72:73], v94 offset:0
    ds_read_b64_tr_b16 v[74:75], v94 offset:8192
    s_waitcnt lgkmcnt(0)
    v_mfma_f32_16x16x32_bf16 v[160:163], v[72:75], v[32:35], v[160:163]
    v_mfma_f32_16x16x32_bf16 v[164:167], v[72:75], v[36:39], v[164:167]
    v_mfma_f32_16x16x32_bf16 v[168:171], v[72:75], v[40:43], v[168:171]
    v_mfma_f32_16x16x32_bf16 v[172:175], v[72:75], v[44:47], v[172:175]
    ds_read_b64_tr_b16 v[76:77], v95 offset:0
    ds_read_b64_tr_b16 v[78:79], v95 offset:8192
    s_waitcnt lgkmcnt(0)
    v_mfma_f32_16x16x32_bf16 v[176:179], v[76:79], v[32:35], v[176:179]
    v_mfma_f32_16x16x32_bf16 v[180:183], v[76:79], v[36:39], v[180:183]
    v_mfma_f32_16x16x32_bf16 v[184:187], v[76:79], v[40:43], v[184:187]
    v_mfma_f32_16x16x32_bf16 v[188:191], v[76:79], v[44:47], v[188:191]
    ds_read_b64_tr_b16 v[64:65], v96 offset:0
    ds_read_b64_tr_b16 v[66:67], v96 offset:8192
    s_waitcnt lgkmcnt(0)
    v_mfma_f32_16x16x32_bf16 v[192:195], v[64:67], v[32:35], v[192:195]
    v_mfma_f32_16x16x32_bf16 v[196:199], v[64:67], v[36:39], v[196:199]
    v_mfma_f32_16x16x32_bf16 v[200:203], v[64:67], v[40:43], v[200:203]
    v_mfma_f32_16x16x32_bf16 v[204:207], v[64:67], v[44:47], v[204:207]
    ds_read_b64_tr_b16 v[68:69], v97 offset:0
    ds_read_b64_tr_b16 v[70:71], v97 offset:8192
    s_waitcnt lgkmcnt(0)
    v_mfma_f32_16x16x32_bf16 v[208:211], v[68:71], v[32:35], v[208:211]
    v_mfma_f32_16x16x32_bf16 v[212:215], v[68:71], v[36:39], v[212:215]
    v_mfma_f32_16x16x32_bf16 v[216:219], v[68:71], v[40:43], v[216:219]
    v_mfma_f32_16x16x32_bf16 v[220:223], v[68:71], v[44:47], v[220:223]
    ds_read_b64_tr_b16 v[72:73], v98 offset:0
    ds_read_b64_tr_b16 v[74:75], v98 offset:8192
    s_waitcnt lgkmcnt(0)
    v_mfma_f32_16x16x32_bf16 v[224:227], v[72:75], v[32:35], v[224:227]
    v_mfma_f32_16x16x32_bf16 v[228:231], v[72:75], v[36:39], v[228:231]
    v_mfma_f32_16x16x32_bf16 v[232:235], v[72:75], v[40:43], v[232:235]
    v_mfma_f32_16x16x32_bf16 v[236:239], v[72:75], v[44:47], v[236:239]
    ds_read_b64_tr_b16 v[76:77], v99 offset:0
    ds_read_b64_tr_b16 v[78:79], v99 offset:8192
    s_waitcnt lgkmcnt(0)
    v_mfma_f32_16x16x32_bf16 v[240:243], v[76:79], v[32:35], v[240:243]
    v_mfma_f32_16x16x32_bf16 v[244:247], v[76:79], v[36:39], v[244:247]
    v_mfma_f32_16x16x32_bf16 v[248:251], v[76:79], v[40:43], v[248:251]
    v_mfma_f32_16x16x32_bf16 v[252:255], v[76:79], v[44:47], v[252:255]
    ds_read_b64_tr_b16 v[64:65], v92 offset:256
    ds_read_b64_tr_b16 v[66:67], v92 offset:8448
    s_waitcnt lgkmcnt(0)
    v_mfma_f32_16x16x32_bf16 a[128:131], v[64:67], v[32:35], a[128:131]
    v_mfma_f32_16x16x32_bf16 a[132:135], v[64:67], v[36:39], a[132:135]
    v_mfma_f32_16x16x32_bf16 a[136:139], v[64:67], v[40:43], a[136:139]
    v_mfma_f32_16x16x32_bf16 a[140:143], v[64:67], v[44:47], a[140:143]
    ds_read_b64_tr_b16 v[68:69], v93 offset:256
    ds_read_b64_tr_b16 v[70:71], v93 offset:8448
    s_waitcnt lgkmcnt(0)
    v_mfma_f32_16x16x32_bf16 a[144:147], v[68:71], v[32:35], a[144:147]
    v_mfma_f32_16x16x32_bf16 a[148:151], v[68:71], v[36:39], a[148:151]
    v_mfma_f32_16x16x32_bf16 a[152:155], v[68:71], v[40:43], a[152:155]
    v_mfma_f32_16x16x32_bf16 a[156:159], v[68:71], v[44:47], a[156:159]
    ds_read_b64_tr_b16 v[72:73], v94 offset:256
    ds_read_b64_tr_b16 v[74:75], v94 offset:8448
    s_waitcnt lgkmcnt(0)
    v_mfma_f32_16x16x32_bf16 a[160:163], v[72:75], v[32:35], a[160:163]
    v_mfma_f32_16x16x32_bf16 a[164:167], v[72:75], v[36:39], a[164:167]
    v_mfma_f32_16x16x32_bf16 a[168:171], v[72:75], v[40:43], a[168:171]
    v_mfma_f32_16x16x32_bf16 a[172:175], v[72:75], v[44:47], a[172:175]
    ds_read_b64_tr_b16 v[76:77], v95 offset:256
    ds_read_b64_tr_b16 v[78:79], v95 offset:8448
    s_waitcnt lgkmcnt(0)
    v_mfma_f32_16x16x32_bf16 a[176:179], v[76:79], v[32:35], a[176:179]
    v_mfma_f32_16x16x32_bf16 a[180:183], v[76:79], v[36:39], a[180:183]
    v_mfma_f32_16x16x32_bf16 a[184:187], v[76:79], v[40:43], a[184:187]
    v_mfma_f32_16x16x32_bf16 a[188:191], v[76:79], v[44:47], a[188:191]
    ds_read_b64_tr_b16 v[64:65], v96 offset:256
    ds_read_b64_tr_b16 v[66:67], v96 offset:8448
    s_waitcnt lgkmcnt(0)
    v_mfma_f32_16x16x32_bf16 a[192:195], v[64:67], v[32:35], a[192:195]
    v_mfma_f32_16x16x32_bf16 a[196:199], v[64:67], v[36:39], a[196:199]
    v_mfma_f32_16x16x32_bf16 a[200:203], v[64:67], v[40:43], a[200:203]
    v_mfma_f32_16x16x32_bf16 a[204:207], v[64:67], v[44:47], a[204:207]
    ds_read_b64_tr_b16 v[68:69], v97 offset:256
    ds_read_b64_tr_b16 v[70:71], v97 offset:8448
    s_waitcnt lgkmcnt(0)
    v_mfma_f32_16x16x32_bf16 a[208:211], v[68:71], v[32:35], a[208:211]
    v_mfma_f32_16x16x32_bf16 a[212:215], v[68:71], v[36:39], a[212:215]
    v_mfma_f32_16x16x32_bf16 a[216:219], v[68:71], v[40:43], a[216:219]
    v_mfma_f32_16x16x32_bf16 a[220:223], v[68:71], v[44:47], a[220:223]
    ds_read_b64_tr_b16 v[72:73], v98 offset:256
    ds_read_b64_tr_b16 v[74:75], v98 offset:8448
    s_waitcnt lgkmcnt(0)
    v_mfma_f32_16x16x32_bf16 a[224:227], v[72:75], v[32:35], a[224:227]
    v_mfma_f32_16x16x32_bf16 a[228:231], v[72:75], v[36:39], a[228:231]
    v_mfma_f32_16x16x32_bf16 a[232:235], v[72:75], v[40:43], a[232:235]
    v_mfma_f32_16x16x32_bf16 a[236:239], v[72:75], v[44:47], a[236:239]
    ds_read_b64_tr_b16 v[76:77], v99 offset:256
    ds_read_b64_tr_b16 v[78:79], v99 offset:8448
    s_waitcnt lgkmcnt(0)
    v_mfma_f32_16x16x32_bf16 a[240:243], v[76:79], v[32:35], a[240:243]
    v_mfma_f32_16x16x32_bf16 a[244:247], v[76:79], v[36:39], a[244:247]
    v_mfma_f32_16x16x32_bf16 a[248:251], v[76:79], v[40:43], a[248:251]
    v_mfma_f32_16x16x32_bf16 a[252:255], v[76:79], v[44:47], a[252:255]
    s_add_u32 s31, s31, 1
    s_cmp_lt_u32 s31, 16
    s_cbranch_scc1 L_slow_p2
    s_nop 7
    v_mov_b32 v120, v80
    v_mov_b32 v121, v81
    v_mov_b32 v122, v82
    v_mov_b32 v123, v83
    s_nop 1
    v_permlane16_swap_b32 v80, v120
    v_permlane16_swap_b32 v81, v121
    v_permlane16_swap_b32 v82, v122
    v_permlane16_swap_b32 v83, v123
    s_nop 1
    v_add_f32 v80, v80, v120
    v_add_f32 v81, v81, v121
    v_add_f32 v82, v82, v122
    v_add_f32 v83, v83, v123
    v_mov_b32 v120, v80
    v_mov_b32 v121, v81
    v_mov_b32 v122, v82
    v_mov_b32 v123, v83
    s_nop 1
    v_permlane32_swap_b32 v80, v120
    v_permlane32_swap_b32 v81, v121
    v_permlane32_swap_b32 v82, v122
    v_permlane32_swap_b32 v83, v123
    s_nop 1
    v_add_f32 v80, v80, v120
    v_add_f32 v81, v81, v121
    v_add_f32 v82, v82, v122
    v_add_f32 v83, v83, v123
    v_rcp_f32 v80, v80
    v_rcp_f32 v81, v81
    v_rcp_f32 v82, v82
    v_rcp_f32 v83, v83
    s_nop 1
    v_mov_b32 v87, v83
    v_mov_b32 v86, v83
    v_mov_b32 v85, v82
    v_mov_b32 v84, v82
    v_mov_b32 v83, v81
    v_mov_b32 v82, v81
    v_mov_b32 v81, v80
    s_add_u32 s52, s39, 0
    v_pk_mul_f32 v[0:1], v[128:129], v[80:81]
    v_pk_mul_f32 v[2:3], v[130:131], v[80:81]
    v_pk_mul_f32 v[4:5], v[144:145], v[80:81]
    v_pk_mul_f32 v[6:7], v[146:147], v[80:81]
    v_cvt_pk_bf16_f32 v8, v0, v1
    v_cvt_pk_bf16_f32 v9, v2, v3
    v_cvt_pk_bf16_f32 v10, v4, v5
    v_cvt_pk_bf16_f32 v11, v6, v7
    s_nop 1
    v_permlane16_swap_b32 v8, v10
    v_permlane16_swap_b32 v9, v11
    s_nop 0
    buffer_store_dwordx4 v[8:11], v109, s[20:23], s52 offen
    s_nop 1
    v_pk_mul_f32 v[0:1], v[160:161], v[80:81]
    v_pk_mul_f32 v[2:3], v[162:163], v[80:81]
    v_pk_mul_f32 v[4:5], v[176:177], v[80:81]
    v_pk_mul_f32 v[6:7], v[178:179], v[80:81]
    v_cvt_pk_bf16_f32 v8, v0, v1
    v_cvt_pk_bf16_f32 v9, v2, v3
    v_cvt_pk_bf16_f32 v10, v4, v5
    v_cvt_pk_bf16_f32 v11, v6, v7
    s_nop 1
    v_permlane16_swap_b32 v8, v10
    v_permlane16_swap_b32 v9, v11
    s_nop 0
    buffer_store_dwordx4 v[8:11], v109, s[20:23], s52 offen offset:64
    s_nop 1
    v_pk_mul_f32 v[0:1], v[192:193], v[80:81]
    v_pk_mul_f32 v[2:3], v[194:195], v[80:81]
    v_pk_mul_f32 v[4:5], v[208:209], v[80:81]
    v_pk_mul_f32 v[6:7], v[210:211], v[80:81]
    v_cvt_pk_bf16_f32 v8, v0, v1
    v_cvt_pk_bf16_f32 v9, v2, v3
    v_cvt_pk_bf16_f32 v10, v4, v5
    v_cvt_pk_bf16_f32 v11, v6, v7
    s_nop 1
    v_permlane16_swap_b32 v8, v10
    v_permlane16_swap_b32 v9, v11
    s_nop 0
    buffer_store_dwordx4 v[8:11], v109, s[20:23], s52 offen offset:128
    s_nop 1
    v_pk_mul_f32 v[0:1], v[224:225], v[80:81]
    v_pk_mul_f32 v[2:3], v[226:227], v[80:81]
    v_pk_mul_f32 v[4:5], v[240:241], v[80:81]
    v_pk_mul_f32 v[6:7], v[242:243], v[80:81]
    v_cvt_pk_bf16_f32 v8, v0, v1
    v_cvt_pk_bf16_f32 v9, v2, v3
    v_cvt_pk_bf16_f32 v10, v4, v5
    v_cvt_pk_bf16_f32 v11, v6, v7
    s_nop 1
    v_permlane16_swap_b32 v8, v10
    v_permlane16_swap_b32 v9, v11
    s_nop 0
    buffer_store_dwordx4 v[8:11], v109, s[20:23], s52 offen offset:192
    s_nop 1
    v_accvgpr_read_b32 v0, a128
    v_accvgpr_read_b32 v1, a129
    v_accvgpr_read_b32 v2, a130
    v_accvgpr_read_b32 v3, a131
    v_accvgpr_read_b32 v4, a144
    v_accvgpr_read_b32 v5, a145
    v_accvgpr_read_b32 v6, a146
    v_accvgpr_read_b32 v7, a147
    v_pk_mul_f32 v[0:1], v[0:1], v[80:81]
    v_pk_mul_f32 v[2:3], v[2:3], v[80:81]
    v_pk_mul_f32 v[4:5], v[4:5], v[80:81]
    v_pk_mul_f32 v[6:7], v[6:7], v[80:81]
    v_cvt_pk_bf16_f32 v8, v0, v1
    v_cvt_pk_bf16_f32 v9, v2, v3
    v_cvt_pk_bf16_f32 v10, v4, v5
    v_cvt_pk_bf16_f32 v11, v6, v7
    s_nop 1
    v_permlane16_swap_b32 v8, v10
    v_permlane16_swap_b32 v9, v11
    s_nop 0
    buffer_store_dwordx4 v[8:11], v109, s[20:23], s52 offen offset:256
    s_nop 1
    v_accvgpr_read_b32 v0, a160
    v_accvgpr_read_b32 v1, a161
    v_accvgpr_read_b32 v2, a162
    v_accvgpr_read_b32 v3, a163
    v_accvgpr_read_b32 v4, a176
    v_accvgpr_read_b32 v5, a177
    v_accvgpr_read_b32 v6, a178
    v_accvgpr_read_b32 v7, a179
    v_pk_mul_f32 v[0:1], v[0:1], v[80:81]
    v_pk_mul_f32 v[2:3], v[2:3], v[80:81]
    v_pk_mul_f32 v[4:5], v[4:5], v[80:81]
    v_pk_mul_f32 v[6:7], v[6:7], v[80:81]
    v_cvt_pk_bf16_f32 v8, v0, v1
    v_cvt_pk_bf16_f32 v9, v2, v3
    v_cvt_pk_bf16_f32 v10, v4, v5
    v_cvt_pk_bf16_f32 v11, v6, v7
    s_nop 1
    v_permlane16_swap_b32 v8, v10
    v_permlane16_swap_b32 v9, v11
    s_nop 0
    buffer_store_dwordx4 v[8:11], v109, s[20:23], s52 offen offset:320
    s_nop 1
    v_accvgpr_read_b32 v0, a192
    v_accvgpr_read_b32 v1, a193
    v_accvgpr_read_b32 v2, a194
    v_accvgpr_read_b32 v3, a195
    v_accvgpr_read_b32 v4, a208
    v_accvgpr_read_b32 v5, a209
    v_accvgpr_read_b32 v6, a210
    v_accvgpr_read_b32 v7, a211
    v_pk_mul_f32 v[0:1], v[0:1], v[80:81]
    v_pk_mul_f32 v[2:3], v[2:3], v[80:81]
    v_pk_mul_f32 v[4:5], v[4:5], v[80:81]
    v_pk_mul_f32 v[6:7], v[6:7], v[80:81]
    v_cvt_pk_bf16_f32 v8, v0, v1
    v_cvt_pk_bf16_f32 v9, v2, v3
    v_cvt_pk_bf16_f32 v10, v4, v5
    v_cvt_pk_bf16_f32 v11, v6, v7
    s_nop 1
    v_permlane16_swap_b32 v8, v10
    v_permlane16_swap_b32 v9, v11
    s_nop 0
    buffer_store_dwordx4 v[8:11], v109, s[20:23], s52 offen offset:384
    s_nop 1
    v_accvgpr_read_b32 v0, a224
    v_accvgpr_read_b32 v1, a225
    v_accvgpr_read_b32 v2, a226
    v_accvgpr_read_b32 v3, a227
    v_accvgpr_read_b32 v4, a240
    v_accvgpr_read_b32 v5, a241
    v_accvgpr_read_b32 v6, a242
    v_accvgpr_read_b32 v7, a243
    v_pk_mul_f32 v[0:1], v[0:1], v[80:81]
    v_pk_mul_f32 v[2:3], v[2:3], v[80:81]
    v_pk_mul_f32 v[4:5], v[4:5], v[80:81]
    v_pk_mul_f32 v[6:7], v[6:7], v[80:81]
    v_cvt_pk_bf16_f32 v8, v0, v1
    v_cvt_pk_bf16_f32 v9, v2, v3
    v_cvt_pk_bf16_f32 v10, v4, v5
    v_cvt_pk_bf16_f32 v11, v6, v7
    s_nop 1
    v_permlane16_swap_b32 v8, v10
    v_permlane16_swap_b32 v9, v11
    s_nop 0
    buffer_store_dwordx4 v[8:11], v109, s[20:23], s52 offen offset:448
    s_nop 1
    s_add_u32 s52, s39, 8192
    v_pk_mul_f32 v[0:1], v[132:133], v[82:83]
    v_pk_mul_f32 v[2:3], v[134:135], v[82:83]
    v_pk_mul_f32 v[4:5], v[148:149], v[82:83]
    v_pk_mul_f32 v[6:7], v[150:151], v[82:83]
    v_cvt_pk_bf16_f32 v8, v0, v1
    v_cvt_pk_bf16_f32 v9, v2, v3
    v_cvt_pk_bf16_f32 v10, v4, v5
    v_cvt_pk_bf16_f32 v11, v6, v7
    s_nop 1
    v_permlane16_swap_b32 v8, v10
    v_permlane16_swap_b32 v9, v11
    s_nop 0
    buffer_store_dwordx4 v[8:11], v109, s[20:23], s52 offen
    s_nop 1
    v_pk_mul_f32 v[0:1], v[164:165], v[82:83]
    v_pk_mul_f32 v[2:3], v[166:167], v[82:83]
    v_pk_mul_f32 v[4:5], v[180:181], v[82:83]
    v_pk_mul_f32 v[6:7], v[182:183], v[82:83]
    v_cvt_pk_bf16_f32 v8, v0, v1
    v_cvt_pk_bf16_f32 v9, v2, v3
    v_cvt_pk_bf16_f32 v10, v4, v5
    v_cvt_pk_bf16_f32 v11, v6, v7
    s_nop 1
    v_permlane16_swap_b32 v8, v10
    v_permlane16_swap_b32 v9, v11
    s_nop 0
    buffer_store_dwordx4 v[8:11], v109, s[20:23], s52 offen offset:64
    s_nop 1
    v_pk_mul_f32 v[0:1], v[196:197], v[82:83]
    v_pk_mul_f32 v[2:3], v[198:199], v[82:83]
    v_pk_mul_f32 v[4:5], v[212:213], v[82:83]
    v_pk_mul_f32 v[6:7], v[214:215], v[82:83]
    v_cvt_pk_bf16_f32 v8, v0, v1
    v_cvt_pk_bf16_f32 v9, v2, v3
    v_cvt_pk_bf16_f32 v10, v4, v5
    v_cvt_pk_bf16_f32 v11, v6, v7
    s_nop 1
    v_permlane16_swap_b32 v8, v10
    v_permlane16_swap_b32 v9, v11
    s_nop 0
    buffer_store_dwordx4 v[8:11], v109, s[20:23], s52 offen offset:128
    s_nop 1
    v_pk_mul_f32 v[0:1], v[228:229], v[82:83]
    v_pk_mul_f32 v[2:3], v[230:231], v[82:83]
    v_pk_mul_f32 v[4:5], v[244:245], v[82:83]
    v_pk_mul_f32 v[6:7], v[246:247], v[82:83]
    v_cvt_pk_bf16_f32 v8, v0, v1
    v_cvt_pk_bf16_f32 v9, v2, v3
    v_cvt_pk_bf16_f32 v10, v4, v5
    v_cvt_pk_bf16_f32 v11, v6, v7
    s_nop 1
    v_permlane16_swap_b32 v8, v10
    v_permlane16_swap_b32 v9, v11
    s_nop 0
    buffer_store_dwordx4 v[8:11], v109, s[20:23], s52 offen offset:192
    s_nop 1
    v_accvgpr_read_b32 v0, a132
    v_accvgpr_read_b32 v1, a133
    v_accvgpr_read_b32 v2, a134
    v_accvgpr_read_b32 v3, a135
    v_accvgpr_read_b32 v4, a148
    v_accvgpr_read_b32 v5, a149
    v_accvgpr_read_b32 v6, a150
    v_accvgpr_read_b32 v7, a151
    v_pk_mul_f32 v[0:1], v[0:1], v[82:83]
    v_pk_mul_f32 v[2:3], v[2:3], v[82:83]
    v_pk_mul_f32 v[4:5], v[4:5], v[82:83]
    v_pk_mul_f32 v[6:7], v[6:7], v[82:83]
    v_cvt_pk_bf16_f32 v8, v0, v1
    v_cvt_pk_bf16_f32 v9, v2, v3
    v_cvt_pk_bf16_f32 v10, v4, v5
    v_cvt_pk_bf16_f32 v11, v6, v7
    s_nop 1
    v_permlane16_swap_b32 v8, v10
    v_permlane16_swap_b32 v9, v11
    s_nop 0
    buffer_store_dwordx4 v[8:11], v109, s[20:23], s52 offen offset:256
    s_nop 1
    v_accvgpr_read_b32 v0, a164
    v_accvgpr_read_b32 v1, a165
    v_accvgpr_read_b32 v2, a166
    v_accvgpr_read_b32 v3, a167
    v_accvgpr_read_b32 v4, a180
    v_accvgpr_read_b32 v5, a181
    v_accvgpr_read_b32 v6, a182
    v_accvgpr_read_b32 v7, a183
    v_pk_mul_f32 v[0:1], v[0:1], v[82:83]
    v_pk_mul_f32 v[2:3], v[2:3], v[82:83]
    v_pk_mul_f32 v[4:5], v[4:5], v[82:83]
    v_pk_mul_f32 v[6:7], v[6:7], v[82:83]
    v_cvt_pk_bf16_f32 v8, v0, v1
    v_cvt_pk_bf16_f32 v9, v2, v3
    v_cvt_pk_bf16_f32 v10, v4, v5
    v_cvt_pk_bf16_f32 v11, v6, v7
    s_nop 1
    v_permlane16_swap_b32 v8, v10
    v_permlane16_swap_b32 v9, v11
    s_nop 0
    buffer_store_dwordx4 v[8:11], v109, s[20:23], s52 offen offset:320
    s_nop 1
    v_accvgpr_read_b32 v0, a196
    v_accvgpr_read_b32 v1, a197
    v_accvgpr_read_b32 v2, a198
    v_accvgpr_read_b32 v3, a199
    v_accvgpr_read_b32 v4, a212
    v_accvgpr_read_b32 v5, a213
    v_accvgpr_read_b32 v6, a214
    v_accvgpr_read_b32 v7, a215
    v_pk_mul_f32 v[0:1], v[0:1], v[82:83]
    v_pk_mul_f32 v[2:3], v[2:3], v[82:83]
    v_pk_mul_f32 v[4:5], v[4:5], v[82:83]
    v_pk_mul_f32 v[6:7], v[6:7], v[82:83]
    v_cvt_pk_bf16_f32 v8, v0, v1
    v_cvt_pk_bf16_f32 v9, v2, v3
    v_cvt_pk_bf16_f32 v10, v4, v5
    v_cvt_pk_bf16_f32 v11, v6, v7
    s_nop 1
    v_permlane16_swap_b32 v8, v10
    v_permlane16_swap_b32 v9, v11
    s_nop 0
    buffer_store_dwordx4 v[8:11], v109, s[20:23], s52 offen offset:384
    s_nop 1
    v_accvgpr_read_b32 v0, a228
    v_accvgpr_read_b32 v1, a229
    v_accvgpr_read_b32 v2, a230
    v_accvgpr_read_b32 v3, a231
    v_accvgpr_read_b32 v4, a244
    v_accvgpr_read_b32 v5, a245
    v_accvgpr_read_b32 v6, a246
    v_accvgpr_read_b32 v7, a247
    v_pk_mul_f32 v[0:1], v[0:1], v[82:83]
    v_pk_mul_f32 v[2:3], v[2:3], v[82:83]
    v_pk_mul_f32 v[4:5], v[4:5], v[82:83]
    v_pk_mul_f32 v[6:7], v[6:7], v[82:83]
    v_cvt_pk_bf16_f32 v8, v0, v1
    v_cvt_pk_bf16_f32 v9, v2, v3
    v_cvt_pk_bf16_f32 v10, v4, v5
    v_cvt_pk_bf16_f32 v11, v6, v7
    s_nop 1
    v_permlane16_swap_b32 v8, v10
    v_permlane16_swap_b32 v9, v11
    s_nop 0
    buffer_store_dwordx4 v[8:11], v109, s[20:23], s52 offen offset:448
    s_nop 1
    s_add_u32 s52, s39, 16384
    v_pk_mul_f32 v[0:1], v[136:137], v[84:85]
    v_pk_mul_f32 v[2:3], v[138:139], v[84:85]
    v_pk_mul_f32 v[4:5], v[152:153], v[84:85]
    v_pk_mul_f32 v[6:7], v[154:155], v[84:85]
    v_cvt_pk_bf16_f32 v8, v0, v1
    v_cvt_pk_bf16_f32 v9, v2, v3
    v_cvt_pk_bf16_f32 v10, v4, v5
    v_cvt_pk_bf16_f32 v11, v6, v7
    s_nop 1
    v_permlane16_swap_b32 v8, v10
    v_permlane16_swap_b32 v9, v11
    s_nop 0
    buffer_store_dwordx4 v[8:11], v109, s[20:23], s52 offen
    s_nop 1
    v_pk_mul_f32 v[0:1], v[168:169], v[84:85]
    v_pk_mul_f32 v[2:3], v[170:171], v[84:85]
    v_pk_mul_f32 v[4:5], v[184:185], v[84:85]
    v_pk_mul_f32 v[6:7], v[186:187], v[84:85]
    v_cvt_pk_bf16_f32 v8, v0, v1
    v_cvt_pk_bf16_f32 v9, v2, v3
    v_cvt_pk_bf16_f32 v10, v4, v5
    v_cvt_pk_bf16_f32 v11, v6, v7
    s_nop 1
    v_permlane16_swap_b32 v8, v10
    v_permlane16_swap_b32 v9, v11
    s_nop 0
    buffer_store_dwordx4 v[8:11], v109, s[20:23], s52 offen offset:64
    s_nop 1
    v_pk_mul_f32 v[0:1], v[200:201], v[84:85]
    v_pk_mul_f32 v[2:3], v[202:203], v[84:85]
    v_pk_mul_f32 v[4:5], v[216:217], v[84:85]
    v_pk_mul_f32 v[6:7], v[218:219], v[84:85]
    v_cvt_pk_bf16_f32 v8, v0, v1
    v_cvt_pk_bf16_f32 v9, v2, v3
    v_cvt_pk_bf16_f32 v10, v4, v5
    v_cvt_pk_bf16_f32 v11, v6, v7
    s_nop 1
    v_permlane16_swap_b32 v8, v10
    v_permlane16_swap_b32 v9, v11
    s_nop 0
    buffer_store_dwordx4 v[8:11], v109, s[20:23], s52 offen offset:128
    s_nop 1
    v_pk_mul_f32 v[0:1], v[232:233], v[84:85]
    v_pk_mul_f32 v[2:3], v[234:235], v[84:85]
    v_pk_mul_f32 v[4:5], v[248:249], v[84:85]
    v_pk_mul_f32 v[6:7], v[250:251], v[84:85]
    v_cvt_pk_bf16_f32 v8, v0, v1
    v_cvt_pk_bf16_f32 v9, v2, v3
    v_cvt_pk_bf16_f32 v10, v4, v5
    v_cvt_pk_bf16_f32 v11, v6, v7
    s_nop 1
    v_permlane16_swap_b32 v8, v10
    v_permlane16_swap_b32 v9, v11
    s_nop 0
    buffer_store_dwordx4 v[8:11], v109, s[20:23], s52 offen offset:192
    s_nop 1
    v_accvgpr_read_b32 v0, a136
    v_accvgpr_read_b32 v1, a137
    v_accvgpr_read_b32 v2, a138
    v_accvgpr_read_b32 v3, a139
    v_accvgpr_read_b32 v4, a152
    v_accvgpr_read_b32 v5, a153
    v_accvgpr_read_b32 v6, a154
    v_accvgpr_read_b32 v7, a155
    v_pk_mul_f32 v[0:1], v[0:1], v[84:85]
    v_pk_mul_f32 v[2:3], v[2:3], v[84:85]
    v_pk_mul_f32 v[4:5], v[4:5], v[84:85]
    v_pk_mul_f32 v[6:7], v[6:7], v[84:85]
    v_cvt_pk_bf16_f32 v8, v0, v1
    v_cvt_pk_bf16_f32 v9, v2, v3
    v_cvt_pk_bf16_f32 v10, v4, v5
    v_cvt_pk_bf16_f32 v11, v6, v7
    s_nop 1
    v_permlane16_swap_b32 v8, v10
    v_permlane16_swap_b32 v9, v11
    s_nop 0
    buffer_store_dwordx4 v[8:11], v109, s[20:23], s52 offen offset:256
    s_nop 1
    v_accvgpr_read_b32 v0, a168
    v_accvgpr_read_b32 v1, a169
    v_accvgpr_read_b32 v2, a170
    v_accvgpr_read_b32 v3, a171
    v_accvgpr_read_b32 v4, a184
    v_accvgpr_read_b32 v5, a185
    v_accvgpr_read_b32 v6, a186
    v_accvgpr_read_b32 v7, a187
    v_pk_mul_f32 v[0:1], v[0:1], v[84:85]
    v_pk_mul_f32 v[2:3], v[2:3], v[84:85]
    v_pk_mul_f32 v[4:5], v[4:5], v[84:85]
    v_pk_mul_f32 v[6:7], v[6:7], v[84:85]
    v_cvt_pk_bf16_f32 v8, v0, v1
    v_cvt_pk_bf16_f32 v9, v2, v3
    v_cvt_pk_bf16_f32 v10, v4, v5
    v_cvt_pk_bf16_f32 v11, v6, v7
    s_nop 1
    v_permlane16_swap_b32 v8, v10
    v_permlane16_swap_b32 v9, v11
    s_nop 0
    buffer_store_dwordx4 v[8:11], v109, s[20:23], s52 offen offset:320
    s_nop 1
    v_accvgpr_read_b32 v0, a200
    v_accvgpr_read_b32 v1, a201
    v_accvgpr_read_b32 v2, a202
    v_accvgpr_read_b32 v3, a203
    v_accvgpr_read_b32 v4, a216
    v_accvgpr_read_b32 v5, a217
    v_accvgpr_read_b32 v6, a218
    v_accvgpr_read_b32 v7, a219
    v_pk_mul_f32 v[0:1], v[0:1], v[84:85]
    v_pk_mul_f32 v[2:3], v[2:3], v[84:85]
    v_pk_mul_f32 v[4:5], v[4:5], v[84:85]
    v_pk_mul_f32 v[6:7], v[6:7], v[84:85]
    v_cvt_pk_bf16_f32 v8, v0, v1
    v_cvt_pk_bf16_f32 v9, v2, v3
    v_cvt_pk_bf16_f32 v10, v4, v5
    v_cvt_pk_bf16_f32 v11, v6, v7
    s_nop 1
    v_permlane16_swap_b32 v8, v10
    v_permlane16_swap_b32 v9, v11
    s_nop 0
    buffer_store_dwordx4 v[8:11], v109, s[20:23], s52 offen offset:384
    s_nop 1
    v_accvgpr_read_b32 v0, a232
    v_accvgpr_read_b32 v1, a233
    v_accvgpr_read_b32 v2, a234
    v_accvgpr_read_b32 v3, a235
    v_accvgpr_read_b32 v4, a248
    v_accvgpr_read_b32 v5, a249
    v_accvgpr_read_b32 v6, a250
    v_accvgpr_read_b32 v7, a251
    v_pk_mul_f32 v[0:1], v[0:1], v[84:85]
    v_pk_mul_f32 v[2:3], v[2:3], v[84:85]
    v_pk_mul_f32 v[4:5], v[4:5], v[84:85]
    v_pk_mul_f32 v[6:7], v[6:7], v[84:85]
    v_cvt_pk_bf16_f32 v8, v0, v1
    v_cvt_pk_bf16_f32 v9, v2, v3
    v_cvt_pk_bf16_f32 v10, v4, v5
    v_cvt_pk_bf16_f32 v11, v6, v7
    s_nop 1
    v_permlane16_swap_b32 v8, v10
    v_permlane16_swap_b32 v9, v11
    s_nop 0
    buffer_store_dwordx4 v[8:11], v109, s[20:23], s52 offen offset:448
    s_nop 1
    s_add_u32 s52, s39, 24576
    v_pk_mul_f32 v[0:1], v[140:141], v[86:87]
    v_pk_mul_f32 v[2:3], v[142:143], v[86:87]
    v_pk_mul_f32 v[4:5], v[156:157], v[86:87]
    v_pk_mul_f32 v[6:7], v[158:159], v[86:87]
    v_cvt_pk_bf16_f32 v8, v0, v1
    v_cvt_pk_bf16_f32 v9, v2, v3
    v_cvt_pk_bf16_f32 v10, v4, v5
    v_cvt_pk_bf16_f32 v11, v6, v7
    s_nop 1
    v_permlane16_swap_b32 v8, v10
    v_permlane16_swap_b32 v9, v11
    s_nop 0
    buffer_store_dwordx4 v[8:11], v109, s[20:23], s52 offen
    s_nop 1
    v_pk_mul_f32 v[0:1], v[172:173], v[86:87]
    v_pk_mul_f32 v[2:3], v[174:175], v[86:87]
    v_pk_mul_f32 v[4:5], v[188:189], v[86:87]
    v_pk_mul_f32 v[6:7], v[190:191], v[86:87]
    v_cvt_pk_bf16_f32 v8, v0, v1
    v_cvt_pk_bf16_f32 v9, v2, v3
    v_cvt_pk_bf16_f32 v10, v4, v5
    v_cvt_pk_bf16_f32 v11, v6, v7
    s_nop 1
    v_permlane16_swap_b32 v8, v10
    v_permlane16_swap_b32 v9, v11
    s_nop 0
    buffer_store_dwordx4 v[8:11], v109, s[20:23], s52 offen offset:64
    s_nop 1
    v_pk_mul_f32 v[0:1], v[204:205], v[86:87]
    v_pk_mul_f32 v[2:3], v[206:207], v[86:87]
    v_pk_mul_f32 v[4:5], v[220:221], v[86:87]
    v_pk_mul_f32 v[6:7], v[222:223], v[86:87]
    v_cvt_pk_bf16_f32 v8, v0, v1
    v_cvt_pk_bf16_f32 v9, v2, v3
    v_cvt_pk_bf16_f32 v10, v4, v5
    v_cvt_pk_bf16_f32 v11, v6, v7
    s_nop 1
    v_permlane16_swap_b32 v8, v10
    v_permlane16_swap_b32 v9, v11
    s_nop 0
    buffer_store_dwordx4 v[8:11], v109, s[20:23], s52 offen offset:128
    s_nop 1
    v_pk_mul_f32 v[0:1], v[236:237], v[86:87]
    v_pk_mul_f32 v[2:3], v[238:239], v[86:87]
    v_pk_mul_f32 v[4:5], v[252:253], v[86:87]
    v_pk_mul_f32 v[6:7], v[254:255], v[86:87]
    v_cvt_pk_bf16_f32 v8, v0, v1
    v_cvt_pk_bf16_f32 v9, v2, v3
    v_cvt_pk_bf16_f32 v10, v4, v5
    v_cvt_pk_bf16_f32 v11, v6, v7
    s_nop 1
    v_permlane16_swap_b32 v8, v10
    v_permlane16_swap_b32 v9, v11
    s_nop 0
    buffer_store_dwordx4 v[8:11], v109, s[20:23], s52 offen offset:192
    s_nop 1
    v_accvgpr_read_b32 v0, a140
    v_accvgpr_read_b32 v1, a141
    v_accvgpr_read_b32 v2, a142
    v_accvgpr_read_b32 v3, a143
    v_accvgpr_read_b32 v4, a156
    v_accvgpr_read_b32 v5, a157
    v_accvgpr_read_b32 v6, a158
    v_accvgpr_read_b32 v7, a159
    v_pk_mul_f32 v[0:1], v[0:1], v[86:87]
    v_pk_mul_f32 v[2:3], v[2:3], v[86:87]
    v_pk_mul_f32 v[4:5], v[4:5], v[86:87]
    v_pk_mul_f32 v[6:7], v[6:7], v[86:87]
    v_cvt_pk_bf16_f32 v8, v0, v1
    v_cvt_pk_bf16_f32 v9, v2, v3
    v_cvt_pk_bf16_f32 v10, v4, v5
    v_cvt_pk_bf16_f32 v11, v6, v7
    s_nop 1
    v_permlane16_swap_b32 v8, v10
    v_permlane16_swap_b32 v9, v11
    s_nop 0
    buffer_store_dwordx4 v[8:11], v109, s[20:23], s52 offen offset:256
    s_nop 1
    v_accvgpr_read_b32 v0, a172
    v_accvgpr_read_b32 v1, a173
    v_accvgpr_read_b32 v2, a174
    v_accvgpr_read_b32 v3, a175
    v_accvgpr_read_b32 v4, a188
    v_accvgpr_read_b32 v5, a189
    v_accvgpr_read_b32 v6, a190
    v_accvgpr_read_b32 v7, a191
    v_pk_mul_f32 v[0:1], v[0:1], v[86:87]
    v_pk_mul_f32 v[2:3], v[2:3], v[86:87]
    v_pk_mul_f32 v[4:5], v[4:5], v[86:87]
    v_pk_mul_f32 v[6:7], v[6:7], v[86:87]
    v_cvt_pk_bf16_f32 v8, v0, v1
    v_cvt_pk_bf16_f32 v9, v2, v3
    v_cvt_pk_bf16_f32 v10, v4, v5
    v_cvt_pk_bf16_f32 v11, v6, v7
    s_nop 1
    v_permlane16_swap_b32 v8, v10
    v_permlane16_swap_b32 v9, v11
    s_nop 0
    buffer_store_dwordx4 v[8:11], v109, s[20:23], s52 offen offset:320
    s_nop 1
    v_accvgpr_read_b32 v0, a204
    v_accvgpr_read_b32 v1, a205
    v_accvgpr_read_b32 v2, a206
    v_accvgpr_read_b32 v3, a207
    v_accvgpr_read_b32 v4, a220
    v_accvgpr_read_b32 v5, a221
    v_accvgpr_read_b32 v6, a222
    v_accvgpr_read_b32 v7, a223
    v_pk_mul_f32 v[0:1], v[0:1], v[86:87]
    v_pk_mul_f32 v[2:3], v[2:3], v[86:87]
    v_pk_mul_f32 v[4:5], v[4:5], v[86:87]
    v_pk_mul_f32 v[6:7], v[6:7], v[86:87]
    v_cvt_pk_bf16_f32 v8, v0, v1
    v_cvt_pk_bf16_f32 v9, v2, v3
    v_cvt_pk_bf16_f32 v10, v4, v5
    v_cvt_pk_bf16_f32 v11, v6, v7
    s_nop 1
    v_permlane16_swap_b32 v8, v10
    v_permlane16_swap_b32 v9, v11
    s_nop 0
    buffer_store_dwordx4 v[8:11], v109, s[20:23], s52 offen offset:384
    s_nop 1
    v_accvgpr_read_b32 v0, a236
    v_accvgpr_read_b32 v1, a237
    v_accvgpr_read_b32 v2, a238
    v_accvgpr_read_b32 v3, a239
    v_accvgpr_read_b32 v4, a252
    v_accvgpr_read_b32 v5, a253
    v_accvgpr_read_b32 v6, a254
    v_accvgpr_read_b32 v7, a255
    v_pk_mul_f32 v[0:1], v[0:1], v[86:87]
    v_pk_mul_f32 v[2:3], v[2:3], v[86:87]
    v_pk_mul_f32 v[4:5], v[4:5], v[86:87]
    v_pk_mul_f32 v[6:7], v[6:7], v[86:87]
    v_cvt_pk_bf16_f32 v8, v0, v1
    v_cvt_pk_bf16_f32 v9, v2, v3
    v_cvt_pk_bf16_f32 v10, v4, v5
    v_cvt_pk_bf16_f32 v11, v6, v7
    s_nop 1
    v_permlane16_swap_b32 v8, v10
    v_permlane16_swap_b32 v9, v11
    s_nop 0
    buffer_store_dwordx4 v[8:11], v109, s[20:23], s52 offen offset:448
    s_nop 1
    s_waitcnt vmcnt(0) lgkmcnt(0)
L_slow_next:
    s_add_u32 s47, s47, 1
    s_cmp_lt_u32 s47, 2
    s_cbranch_scc1 L_slow_unit
L_slow_done:
    s_branch L_end
L_pf_0:
    s_lshl_b32 s57, s30, 6
    v_add_u32 v123, s57, v118
    s_getpc_b64 s[98:99]
L_pc_u0:
    s_sub_u32 s98, s98, L_pc_u0-L_fe0
    s_subb_u32 s99, s99, 0
    v_lshlrev_b32 v122, 7, v123
    v_min_u32 v122, L_loop1_end-L_fe0-4, v122
    v_mov_b32 v121, s99
    v_add_co_u32 v120, vcc, s98, v122
    s_nop 1
    v_addc_co_u32 v121, vcc, 0, v121, vcc
    global_load_dword v119, v[120:121], off
    s_branch L_pfret_0
L_pf_1:
    s_lshl_b32 s57, s30, 6
    v_add_u32 v123, s57, v118
    s_getpc_b64 s[98:99]
L_pc_u1:
    s_sub_u32 s98, s98, L_pc_u1-L_fe1
    s_subb_u32 s99, s99, 0
    v_lshlrev_b32 v122, 6, v123
    v_min_u32 v122, L_fe1_end-L_fe1-4, v122
    v_mov_b32 v121, s99
    v_add_co_u32 v120, vcc, s98, v122
    s_nop 1
    v_addc_co_u32 v121, vcc, 0, v121, vcc
    global_load_dword v119, v[120:121], off
    s_branch L_pfret_1
L_end:
    s_endpgm
.section .rodata,"a"
.p2align 6
.amdhsa_kernel standalone__gqa_softmax__near_ridge_kernel
  .amdhsa_next_free_vgpr 512
  .amdhsa_next_free_sgpr 102
  .amdhsa_accum_offset 256
  .amdhsa_group_segment_fixed_size 0
  .amdhsa_kernarg_size 48
  .amdhsa_user_sgpr_count 2
  .amdhsa_user_sgpr_kernarg_segment_ptr 1
  .amdhsa_system_sgpr_workgroup_id_x 1
  .amdhsa_float_denorm_mode_32 3
.end_amdhsa_kernel
```
